```python
import torch

def _softmax(x, axis=-1):
    return torch.softmax(x, dim=axis)
def _gelu(x):
    return torch.nn.functional.gelu(x, approximate="tanh")
def _silu(x):
    return torch.nn.functional.silu(x)
def _sigmoid(x):
    return torch.sigmoid(x)
def _layernorm(x, axis=-1, eps=1e-5):
    m = x.mean(dim=axis, keepdim=True)
    v = x.var(dim=axis, keepdim=True, unbiased=False)
    return (x - m) / torch.sqrt(v + eps)
def _scatter_add(tgt, idx, src, axis=0):
    return tgt.clone().index_add_(axis, idx, src)
def _segment_sum(src, seg, n):
    out = torch.zeros((n,) + src.shape[1:], dtype=src.dtype)
    return out.index_add_(0, seg, src)
def _pad(x, pw):
    flat = tuple(v for pair in reversed(pw) for v in pair)
    return torch.nn.functional.pad(x, flat)

kernel_name = 'parallel_sum__sliding_block_cached__geglu_ffn__decode'

def setup_inputs():

    _w = (lambda a: (lambda t: t.to(torch.bfloat16) if t.is_floating_point() else t)(torch.as_tensor(a)))
    def _A_setup():
        B, Sq, D = 4, 1, 640
        Hq, Hkv, Sk, Dh = 32, 32, 8192, 192
        assert Hq % Hkv == 0, (Hq, Hkv)
        return {
            "x": _w((lambda *s: torch.randn(*s, dtype=torch.bfloat16) * 0.05)(B, Sq, D)),
            "k_cache": _w((lambda *s: torch.randn(*s, dtype=torch.bfloat16) * 3.2)(B, Hkv, Sk, Dh)),
            "v_cache": _w((lambda *s: torch.randn(*s, dtype=torch.bfloat16) * 1.6)(B, Hkv, Sk, Dh)),
            "wq": _w((lambda *s: torch.randn(*s, dtype=torch.bfloat16) * 3.2)(D, Hq * Dh) * (D ** -0.5)),
            "wo": _w((lambda *s: torch.randn(*s, dtype=torch.bfloat16) * 1.6)(Hq * Dh, D) * ((Hq * Dh) ** -0.5)),
        }
    _A_in = _A_setup()

    def _B_setup():
        B, S, D, F = 4, 1, 640, 1536
        return {
            "x": _w((lambda *s: torch.randn(*s, dtype=torch.bfloat16) * 0.05)(B, S, D)),
            "w_gate": _w((lambda *s: torch.randn(*s, dtype=torch.bfloat16) * 0.05)(D, F)),
            "w_up": _w((lambda *s: torch.randn(*s, dtype=torch.bfloat16) * 0.05)(D, F)),
            "w_down": _w((lambda *s: torch.randn(*s, dtype=torch.bfloat16) * 0.05)(F, D)),
        }
    _B_in = _B_setup()

    return {
        "A_x": _A_in["x"],
        "A_k_cache": _A_in["k_cache"],
        "A_v_cache": _A_in["v_cache"],
        "A_wq": _A_in["wq"],
        "A_wo": _A_in["wo"],
        "B_x": _B_in["x"],
        "B_w_gate": _B_in["w_gate"],
        "B_w_up": _B_in["w_up"],
        "B_w_down": _B_in["w_down"],
    }

def reference(A_x, A_k_cache, A_v_cache, A_wq, A_wo, B_x, B_w_gate, B_w_up, B_w_down):
    def _A_ref(x, k_cache, v_cache, wq, wo):
        B, Sq, D = x.shape
        Hq, Dh = 32, 192
        Hkv, Sk = k_cache.shape[1], k_cache.shape[2]
        W = min(4096, max(256, Sk // 4))
        rep = Hq // Hkv
        q = (lambda x, *d: x.permute(*d))((x @ wq).reshape(B, Sq, Hq, Dh), 0, 2, 1, 3)
        k = (lambda x, n, axis: torch.repeat_interleave(x, n, dim=axis))(k_cache[:, :, Sk - W:, :], rep, axis=1)
        v = (lambda x, n, axis: torch.repeat_interleave(x, n, dim=axis))(v_cache[:, :, Sk - W:, :], rep, axis=1)
        scores = torch.einsum("bhqd,bhkd->bhqk", q, k) * (Dh ** -0.5)
        p = _softmax(scores, axis=-1)
        o = torch.einsum("bhqk,bhkd->bhqd", p, v)
        return (lambda x, *d: x.permute(*d))(o, 0, 2, 1, 3).reshape(B, Sq, Hq * Dh) @ wo

    def _B_ref(x, w_gate, w_up, w_down):
        return (_gelu(x @ w_gate) * (x @ w_up)) @ w_down

    x = A_x
    xn = _layernorm(x, axis=-1)
    return x + _A_ref(xn, A_k_cache, A_v_cache, A_wq, A_wo) + _B_ref(xn, B_w_gate, B_w_up, B_w_down)
```

```asm
; @launch grid=(256,1,1) block=(320,1,1) lds=163744
.amdgcn_target "amdgcn-amd-amdhsa--gfx950"
.text
.globl parallel_sum__sliding_block_cached__geglu_ffn__decode_kernel
.p2align 8
.type parallel_sum__sliding_block_cached__geglu_ffn__decode_kernel,@function
parallel_sum__sliding_block_cached__geglu_ffn__decode_kernel:
    s_cmp_ge_u32 s2, 256
    s_cbranch_scc1 L_end
    s_load_dwordx16 s[48:63], s[0:1], 0
    s_load_dwordx8 s[64:71], s[0:1], 64
    v_lshrrev_b32 v1, 6, v0
    s_and_b32 s4, s2, 31
    v_readfirstlane_b32 s3, v1
    v_and_b32 v1, 63, v0
    s_lshr_b32 s5, s2, 5
    v_lshlrev_b32 v2, 4, v1
    s_mul_i32 s78, s4, 3145728
    s_add_u32 s78, s78, 2359296
    s_mov_b32 s10, 302776320
    s_mov_b32 s11, 0x20000
    s_mov_b32 s14, 302751744
    s_mov_b32 s15, 0x20000
    s_mul_i32 s40, s3, 36864
    s_and_b32 s76, s3, 1
    s_mul_i32 s76, s76, 100638720
    s_mul_i32 s77, s3, 24576
    s_add_u32 s76, s76, s77
    s_mul_i32 s77, s5, 3072
    s_add_u32 s76, s76, s77
    s_mov_b32 m0, s40
    s_add_u32 s77, s40, 3072
    s_waitcnt lgkmcnt(0)
    s_add_u32 s8, s50, s78
    s_addc_u32 s9, s51, 0
    s_add_u32 s12, s8, 24576
    s_addc_u32 s13, s9, 0
    s_cmp_eq_u32 s3, 4
    s_cbranch_scc1 L_nofast
    buffer_load_dwordx4 v2, s[8:11], s76 offen offset:0 nt lds
    buffer_load_dwordx4 v2, s[8:11], s76 offen offset:1024 nt lds
    buffer_load_dwordx4 v2, s[8:11], s76 offen offset:2048 nt lds
    s_mov_b32 m0, s77
    s_nop 0
    buffer_load_dwordx4 v2, s[12:15], s76 offen offset:0 nt lds
    buffer_load_dwordx4 v2, s[12:15], s76 offen offset:1024 nt lds
    buffer_load_dwordx4 v2, s[12:15], s76 offen offset:2048 nt lds
L_nofast:
    s_add_u32 s52, s52, s78
    s_addc_u32 s53, s53, 0
    s_add_u32 s6, s5, 5
    s_and_b32 s6, s6, 7
    s_mov_b32 s19, 0x20000
    s_mov_b32 s23, 0x20000
    s_mov_b32 s27, 0x20000
    s_mov_b32 s31, 0x20000
    s_mov_b32 s35, 0x20000
    s_mov_b32 s39, 0x20000
    s_mov_b32 s18, 0x800000
    s_mov_b32 s26, 7864320
    s_mov_b32 s30, 1966080
    s_mov_b32 s34, 5120
    s_mov_b32 s38, 5120
    s_and_b32 s76, s4, 7
    s_lshl_b32 s100, s76, 2
    s_lshr_b32 s77, s4, 3
    s_add_u32 s100, s100, s77
    s_lshl_b32 s76, s76, 1
    s_and_b32 s77, s77, 1
    s_add_u32 s76, s76, s77
    s_mul_i32 s76, s76, 3
    s_add_u32 s77, s76, 2
    s_cmp_eq_u32 s6, 6
    s_cselect_b32 s46, s76, s77
    s_cselect_b32 s47, 2, 1
    s_mov_b32 s73, 24576
    s_mul_i32 s72, s4, 384
    s_cmp_lt_u32 s6, 6
    s_cselect_b32 s46, s6, s46
    s_cselect_b32 s72, s72, 0
    s_mov_b32 s44, 3072
    s_cselect_b32 s44, 12288, s44
    s_add_u32 s73, s73, s40
    v_lshrrev_b32 v65, 3, v1
    v_and_b32 v66, 6, v65
    v_and_b32 v67, 7, v1
    v_xor_b32 v66, v66, v67
    v_mul_u32_u24 v65, s44, v65
    v_lshl_add_u32 v65, v66, 4, v65
    s_lshl_b32 s45, s44, 3
    v_lshlrev_b32 v64, 2, v1
    s_mul_i32 s76, s3, 1280
    v_mov_b32 v195, 163648
    s_mov_b32 s32, s48
    s_mov_b32 s33, s49
    s_cmp_lt_u32 s4, 16
    s_cselect_b32 s60, s60, s62
    s_cselect_b32 s61, s61, s63
    s_cmp_lt_u32 s6, 6
    s_cselect_b32 s20, s54, s60
    s_cselect_b32 s21, s55, s61
    s_cselect_b32 s22, s26, s30
    s_mov_b32 s24, s56
    s_mov_b32 s25, s57
    s_mov_b32 s28, s64
    s_mov_b32 s29, s65
    s_mov_b32 s36, s66
    s_mov_b32 s37, s67
    s_mov_b32 s16, s70
    s_mov_b32 s17, s71
    s_cmp_eq_u32 s3, 4
    s_cbranch_scc1 L_loader
    buffer_load_dwordx4 v[36:39], v2, s[32:35], s76 offen
    buffer_load_dword v40, v64, s[32:35], s76 offen offset:1024
    s_mov_b32 s77, s73
    s_and_b32 s76, s46, 1
    s_mul_i32 s76, s76, 320
    s_mul_i32 s79, s3, 80
    s_add_u32 s76, s76, s79
    s_mul_i32 s76, s76, s44
    s_add_u32 s76, s76, s72
    s_lshr_b32 s79, s46, 1
    s_lshl_b32 s79, s79, 7
    s_add_u32 s76, s76, s79
    s_mov_b32 m0, s77
    s_add_u32 s77, s77, 1024
    buffer_load_dwordx4 v65, s[20:23], s76 offen nt lds
    s_add_u32 s76, s76, s45
    s_mov_b32 m0, s77
    s_add_u32 s77, s77, 1024
    buffer_load_dwordx4 v65, s[20:23], s76 offen nt lds
    s_add_u32 s76, s76, s45
    s_mov_b32 m0, s77
    s_add_u32 s77, s77, 1024
    buffer_load_dwordx4 v65, s[20:23], s76 offen nt lds
    s_add_u32 s76, s76, s45
    s_mov_b32 m0, s77
    s_add_u32 s77, s77, 1024
    buffer_load_dwordx4 v65, s[20:23], s76 offen nt lds
    s_add_u32 s76, s76, s45
    s_mov_b32 m0, s77
    s_add_u32 s77, s77, 1024
    buffer_load_dwordx4 v65, s[20:23], s76 offen nt lds
    s_add_u32 s76, s76, s45
    s_mov_b32 m0, s77
    s_add_u32 s77, s77, 1024
    buffer_load_dwordx4 v65, s[20:23], s76 offen nt lds
    s_add_u32 s76, s76, s45
    s_mov_b32 m0, s77
    s_add_u32 s77, s77, 1024
    buffer_load_dwordx4 v65, s[20:23], s76 offen nt lds
    s_add_u32 s76, s76, s45
    s_mov_b32 m0, s77
    s_add_u32 s77, s77, 1024
    buffer_load_dwordx4 v65, s[20:23], s76 offen nt lds
    s_add_u32 s76, s76, s45
    s_mov_b32 m0, s77
    s_add_u32 s77, s77, 1024
    buffer_load_dwordx4 v65, s[20:23], s76 offen nt lds
    s_add_u32 s76, s76, s45
    s_mov_b32 m0, s77
    s_add_u32 s77, s77, 1024
    buffer_load_dwordx4 v65, s[20:23], s76 offen nt lds
    s_add_u32 s76, s76, s45
    v_mov_b32 v15, v65
    s_barrier
    s_load_dword s7, s[70:71], 0
    s_mov_b32 s74, 0
    v_mov_b32 v197, 1
    s_lshl_b32 s76, s3, 2
    s_add_u32 s76, s76, 163664
    v_mov_b32 v196, s76
    s_add_u32 s42, s40, 36864
    s_mov_b32 s41, s40
    v_bfe_u32 v68, v1, 2, 2
    v_mul_u32_u24 v68, 1344, v68
    v_lshrrev_b32 v69, 4, v1
    v_lshl_add_u32 v68, v69, 3, v68
    s_mul_i32 s76, s3, 160
    s_add_u32 s76, s76, 147456
    v_add_u32 v12, s76, v68
    v_and_b32 v68, 15, v1
    v_lshlrev_b32 v68, 2, v68
    v_lshl_add_u32 v68, v69, 8, v68
    s_lshl_b32 s76, s3, 10
    s_add_u32 s76, s76, 152832
    v_add_u32 v14, s76, v68
    v_add_u32 v13, 152832, v2
    v_lshrrev_b32 v68, 2, v1
    v_and_b32 v69, 3, v1
    v_lshlrev_b32 v69, 3, v69
    v_lshl_add_u32 v69, v68, 7, v69
    v_add_u32 v69, s73, v69
    v_bfe_u32 v68, v1, 3, 2
    v_xor_b32 v70, 0, v68
    v_lshl_add_u32 v60, v70, 5, v69
    v_xor_b32 v70, 1, v68
    v_lshl_add_u32 v61, v70, 5, v69
    v_xor_b32 v70, 2, v68
    v_lshl_add_u32 v62, v70, 5, v69
    v_xor_b32 v70, 3, v68
    v_lshl_add_u32 v63, v70, 5, v69
    s_mul_i32 s76, s4, 6
    s_lshr_b32 s77, s4, 4
    s_mul_i32 s77, s77, 48
    s_add_u32 s77, s77, 192
    s_cmp_lt_u32 s6, 6
    s_cselect_b32 s76, s76, s77
    s_lshl_b32 s76, s76, 10
    s_add_u32 s53, s76, 0x10000
    s_waitcnt vmcnt(10)
    v_lshlrev_b32 v48, 16, v36
    v_and_b32 v49, 0xffff0000, v36
    v_lshlrev_b32 v50, 16, v37
    v_and_b32 v51, 0xffff0000, v37
    v_lshlrev_b32 v52, 16, v38
    v_and_b32 v53, 0xffff0000, v38
    v_lshlrev_b32 v54, 16, v39
    v_and_b32 v55, 0xffff0000, v39
    v_lshlrev_b32 v56, 16, v40
    v_and_b32 v57, 0xffff0000, v40
    v_add_f32 v64, v48, v49
    v_add_f32 v64, v64, v50
    v_add_f32 v64, v64, v51
    v_add_f32 v64, v64, v52
    v_add_f32 v64, v64, v53
    v_add_f32 v64, v64, v54
    v_add_f32 v64, v64, v55
    v_add_f32 v64, v64, v56
    v_add_f32 v64, v64, v57
    s_nop 1
    v_add_f32_dpp v64, v64, v64 quad_perm:[1,0,3,2] row_mask:0xf bank_mask:0xf
    s_nop 1
    v_add_f32_dpp v64, v64, v64 quad_perm:[2,3,0,1] row_mask:0xf bank_mask:0xf
    s_nop 1
    v_add_f32_dpp v64, v64, v64 row_half_mirror row_mask:0xf bank_mask:0xf
    s_nop 1
    v_add_f32_dpp v64, v64, v64 row_mirror row_mask:0xf bank_mask:0xf
    v_mov_b32 v65, v64
    s_nop 1
    v_permlane16_swap_b32 v64, v65
    v_add_f32 v64, v64, v65
    v_mov_b32 v65, v64
    s_nop 1
    v_permlane32_swap_b32 v64, v65
    v_add_f32 v64, v64, v65
    v_mul_f32 v64, 0x3acccccd, v64
    v_sub_f32 v66, v48, v64
    v_mul_f32 v67, v66, v66
    v_sub_f32 v66, v49, v64
    v_fmac_f32 v67, v66, v66
    v_sub_f32 v66, v50, v64
    v_fmac_f32 v67, v66, v66
    v_sub_f32 v66, v51, v64
    v_fmac_f32 v67, v66, v66
    v_sub_f32 v66, v52, v64
    v_fmac_f32 v67, v66, v66
    v_sub_f32 v66, v53, v64
    v_fmac_f32 v67, v66, v66
    v_sub_f32 v66, v54, v64
    v_fmac_f32 v67, v66, v66
    v_sub_f32 v66, v55, v64
    v_fmac_f32 v67, v66, v66
    v_sub_f32 v66, v56, v64
    v_fmac_f32 v67, v66, v66
    v_sub_f32 v66, v57, v64
    v_fmac_f32 v67, v66, v66
    s_nop 1
    v_add_f32_dpp v67, v67, v67 quad_perm:[1,0,3,2] row_mask:0xf bank_mask:0xf
    s_nop 1
    v_add_f32_dpp v67, v67, v67 quad_perm:[2,3,0,1] row_mask:0xf bank_mask:0xf
    s_nop 1
    v_add_f32_dpp v67, v67, v67 row_half_mirror row_mask:0xf bank_mask:0xf
    s_nop 1
    v_add_f32_dpp v67, v67, v67 row_mirror row_mask:0xf bank_mask:0xf
    v_mov_b32 v65, v67
    s_nop 1
    v_permlane16_swap_b32 v67, v65
    v_add_f32 v67, v67, v65
    v_mov_b32 v65, v67
    s_nop 1
    v_permlane32_swap_b32 v67, v65
    v_add_f32 v67, v67, v65
    v_mul_f32 v67, 0x3acccccd, v67
    v_cvt_pk_bf16_f32 v65, v64, v67
    v_lshlrev_b32 v64, 16, v65
    v_and_b32 v67, 0xffff0000, v65
    v_add_f32 v67, 0x3727c5ac, v67
    v_cvt_pk_bf16_f32 v67, v67, v67
    v_and_b32 v67, 0xffff0000, v67
    v_sqrt_f32 v67, v67
    s_nop 0
    v_cvt_pk_bf16_f32 v67, v67, v67
    v_and_b32 v67, 0xffff0000, v67
    v_rcp_f32 v67, v67
    v_sub_f32 v48, v48, v64
    v_sub_f32 v49, v49, v64
    v_cvt_pk_bf16_f32 v65, v48, v49
    v_lshlrev_b32 v48, 16, v65
    v_and_b32 v49, 0xffff0000, v65
    v_mul_f32 v48, v48, v67
    v_mul_f32 v49, v49, v67
    v_cvt_pk_bf16_f32 v36, v48, v49
    v_sub_f32 v50, v50, v64
    v_sub_f32 v51, v51, v64
    v_cvt_pk_bf16_f32 v65, v50, v51
    v_lshlrev_b32 v50, 16, v65
    v_and_b32 v51, 0xffff0000, v65
    v_mul_f32 v50, v50, v67
    v_mul_f32 v51, v51, v67
    v_cvt_pk_bf16_f32 v37, v50, v51
    v_sub_f32 v52, v52, v64
    v_sub_f32 v53, v53, v64
    v_cvt_pk_bf16_f32 v65, v52, v53
    v_lshlrev_b32 v52, 16, v65
    v_and_b32 v53, 0xffff0000, v65
    v_mul_f32 v52, v52, v67
    v_mul_f32 v53, v53, v67
    v_cvt_pk_bf16_f32 v38, v52, v53
    v_sub_f32 v54, v54, v64
    v_sub_f32 v55, v55, v64
    v_cvt_pk_bf16_f32 v65, v54, v55
    v_lshlrev_b32 v54, 16, v65
    v_and_b32 v55, 0xffff0000, v65
    v_mul_f32 v54, v54, v67
    v_mul_f32 v55, v55, v67
    v_cvt_pk_bf16_f32 v39, v54, v55
    v_sub_f32 v56, v56, v64
    v_sub_f32 v57, v57, v64
    v_cvt_pk_bf16_f32 v65, v56, v57
    v_lshlrev_b32 v56, 16, v65
    v_and_b32 v57, 0xffff0000, v65
    v_mul_f32 v56, v56, v67
    v_mul_f32 v57, v57, v67
    v_cvt_pk_bf16_f32 v40, v56, v57
    s_mul_i32 s76, s3, 1344
    s_add_u32 s76, s76, 147456
    v_add_u32 v64, s76, v2
    v_lshl_add_u32 v65, v1, 2, s76
    ds_write_b128 v64, v[36:39]
    ds_write_b32 v65, v40 offset:1024
    s_waitcnt lgkmcnt(0)
    s_mov_b64 exec, 1
    ds_add_u32 v195, v197 offset:8
    s_mov_b64 exec, -1
    s_add_u32 s74, s74, 4
    s_mov_b32 s83, 3200000
L_bar0:
    ds_read_b32 v200, v195 offset:8
    s_sub_u32 s83, s83, 1
    s_waitcnt lgkmcnt(0)
    v_readfirstlane_b32 s79, v200
    s_cbranch_scc1 L_bard0
    s_cmp_lt_u32 s79, s74
    s_cbranch_scc1 L_bar0
L_bard0:
    s_add_u32 s7, s7, 0x9e3779b9
    s_bfe_u32 s76, s7, 0x80000
    v_mov_b32 v72, s76
    s_bfe_u32 s76, s7, 0x80008
    v_mov_b32 v73, s76
    s_bfe_u32 s76, s7, 0x80010
    v_mov_b32 v74, s76
    s_bfe_u32 s76, s7, 0x80018
    v_mov_b32 v75, s76
    s_mov_b32 s82, 0xff
L_u_mm:
    s_and_b32 s76, s46, 1
    s_mul_i32 s77, s76, 640
    v_add_u32 v64, s77, v12
    ds_read2_b64 v[36:39], v64 offset0:0 offset1:4
    ds_read2_b64 v[40:43], v64 offset0:8 offset1:12
    ds_read_b64 v[44:45], v64 offset:128
    s_lshl_b32 s78, s46, 10
    s_add_u32 s78, s78, s53
    s_waitcnt vmcnt(0)
    ds_read_b64_tr_b16 v[96:97], v60 offset:8192
    ds_read_b64_tr_b16 v[106:107], v61 offset:8192
    ds_read_b64_tr_b16 v[116:117], v62 offset:8192
    ds_read_b64_tr_b16 v[126:127], v63 offset:8192
    ds_read_b64_tr_b16 v[88:89], v60 offset:0
    ds_read_b64_tr_b16 v[90:91], v60 offset:2048
    ds_read_b64_tr_b16 v[98:99], v61 offset:0
    ds_read_b64_tr_b16 v[100:101], v61 offset:2048
    ds_read_b64_tr_b16 v[108:109], v62 offset:0
    ds_read_b64_tr_b16 v[110:111], v62 offset:2048
    ds_read_b64_tr_b16 v[118:119], v63 offset:0
    ds_read_b64_tr_b16 v[120:121], v63 offset:2048
    s_waitcnt lgkmcnt(8)
    v_mfma_f32_16x16x16_bf16 v[148:151], v[44:45], v[96:97], 0
    v_mfma_f32_16x16x16_bf16 v[152:155], v[44:45], v[106:107], 0
    v_mfma_f32_16x16x16_bf16 v[156:159], v[44:45], v[116:117], 0
    v_mfma_f32_16x16x16_bf16 v[160:163], v[44:45], v[126:127], 0
    ds_read_b64_tr_b16 v[92:93], v60 offset:4096
    ds_read_b64_tr_b16 v[94:95], v60 offset:6144
    ds_read_b64_tr_b16 v[102:103], v61 offset:4096
    ds_read_b64_tr_b16 v[104:105], v61 offset:6144
    ds_read_b64_tr_b16 v[112:113], v62 offset:4096
    ds_read_b64_tr_b16 v[114:115], v62 offset:6144
    ds_read_b64_tr_b16 v[122:123], v63 offset:4096
    ds_read_b64_tr_b16 v[124:125], v63 offset:6144
    s_waitcnt lgkmcnt(8)
    v_mfma_f32_16x16x32_bf16 v[148:151], v[36:39], v[88:91], v[148:151]
    v_mfma_f32_16x16x32_bf16 v[152:155], v[36:39], v[98:101], v[152:155]
    v_mfma_f32_16x16x32_bf16 v[156:159], v[36:39], v[108:111], v[156:159]
    v_mfma_f32_16x16x32_bf16 v[160:163], v[36:39], v[118:121], v[160:163]
    s_waitcnt lgkmcnt(6)
    v_mfma_f32_16x16x32_bf16 v[148:151], v[40:43], v[92:95], v[148:151]
    s_waitcnt lgkmcnt(4)
    v_mfma_f32_16x16x32_bf16 v[152:155], v[40:43], v[102:105], v[152:155]
    s_waitcnt lgkmcnt(2)
    v_mfma_f32_16x16x32_bf16 v[156:159], v[40:43], v[112:115], v[156:159]
    s_waitcnt lgkmcnt(0)
    v_mfma_f32_16x16x32_bf16 v[160:163], v[40:43], v[122:125], v[160:163]
    s_nop 3
    ds_write_b32 v14, v148 offset:0
    ds_write_b32 v14, v152 offset:64
    ds_write_b32 v14, v156 offset:128
    s_nop 0
    ds_write_b32 v14, v160 offset:192
    s_waitcnt lgkmcnt(0)
    s_mov_b64 exec, 1
    ds_add_u32 v195, v197 offset:8
    s_mov_b64 exec, -1
    s_add_u32 s74, s74, 4
    s_mov_b32 s83, 3200000
L_bar1:
    ds_read_b32 v200, v195 offset:8
    s_sub_u32 s83, s83, 1
    s_waitcnt lgkmcnt(0)
    v_readfirstlane_b32 s79, v200
    s_cbranch_scc1 L_bard1
    s_cmp_lt_u32 s79, s74
    s_cbranch_scc1 L_bar1
L_bard1:
    s_cmp_lg_u32 s3, 0
    s_cbranch_scc1 L_u_nopub
    ds_read_b128 v[164:167], v13 offset:0
    ds_read_b128 v[168:171], v13 offset:1024
    ds_read_b128 v[172:175], v13 offset:2048
    ds_read_b128 v[176:179], v13 offset:3072
    s_waitcnt lgkmcnt(0)
    v_add_f32 v164, v164, v168
    v_add_f32 v172, v172, v176
    v_add_f32 v165, v165, v169
    v_add_f32 v173, v173, v177
    v_add_f32 v166, v166, v170
    v_add_f32 v174, v174, v178
    v_add_f32 v167, v167, v171
    v_add_f32 v175, v175, v179
    v_add_f32 v164, v164, v172
    v_add_f32 v165, v165, v173
    v_add_f32 v166, v166, v174
    v_add_f32 v167, v167, v175
    v_add_u32 v164, 0x80, v164
    v_add_u32 v165, 0x80, v165
    v_add_u32 v166, 0x80, v166
    v_add_u32 v167, 0x80, v167
    v_bfi_b32 v164, s82, v72, v164
    v_bfi_b32 v165, s82, v73, v165
    v_bfi_b32 v166, s82, v74, v166
    v_bfi_b32 v167, s82, v75, v167
    s_cmp_ge_u32 s6, 6
    s_cbranch_scc1 L_u_far
    buffer_store_dwordx4 v[164:167], v2, s[16:19], s78 offen
    s_branch L_u_nopub
L_u_far:
    buffer_store_dwordx4 v[164:167], v2, s[16:19], s78 offen sc1
L_u_nopub:
    v_add_u32 v14, 4096, v14
    v_add_u32 v13, 4096, v13
    s_add_u32 s46, s46, 1
    s_sub_u32 s47, s47, 1
    s_cmp_eq_u32 s47, 0
    s_cbranch_scc1 L_u_done
    s_mov_b32 s77, s73
    s_and_b32 s76, s46, 1
    s_mul_i32 s76, s76, 320
    s_mul_i32 s79, s3, 80
    s_add_u32 s76, s76, s79
    s_mul_i32 s76, s76, s44
    s_add_u32 s76, s76, s72
    s_lshr_b32 s79, s46, 1
    s_lshl_b32 s79, s79, 7
    s_add_u32 s76, s76, s79
    s_mov_b32 m0, s77
    s_add_u32 s77, s77, 1024
    buffer_load_dwordx4 v15, s[20:23], s76 offen nt lds
    s_add_u32 s76, s76, s45
    s_mov_b32 m0, s77
    s_add_u32 s77, s77, 1024
    buffer_load_dwordx4 v15, s[20:23], s76 offen nt lds
    s_add_u32 s76, s76, s45
    s_mov_b32 m0, s77
    s_add_u32 s77, s77, 1024
    buffer_load_dwordx4 v15, s[20:23], s76 offen nt lds
    s_add_u32 s76, s76, s45
    s_mov_b32 m0, s77
    s_add_u32 s77, s77, 1024
    buffer_load_dwordx4 v15, s[20:23], s76 offen nt lds
    s_add_u32 s76, s76, s45
    s_mov_b32 m0, s77
    s_add_u32 s77, s77, 1024
    buffer_load_dwordx4 v15, s[20:23], s76 offen nt lds
    s_add_u32 s76, s76, s45
    s_mov_b32 m0, s77
    s_add_u32 s77, s77, 1024
    buffer_load_dwordx4 v15, s[20:23], s76 offen nt lds
    s_add_u32 s76, s76, s45
    s_mov_b32 m0, s77
    s_add_u32 s77, s77, 1024
    buffer_load_dwordx4 v15, s[20:23], s76 offen nt lds
    s_add_u32 s76, s76, s45
    s_mov_b32 m0, s77
    s_add_u32 s77, s77, 1024
    buffer_load_dwordx4 v15, s[20:23], s76 offen nt lds
    s_add_u32 s76, s76, s45
    s_mov_b32 m0, s77
    s_add_u32 s77, s77, 1024
    buffer_load_dwordx4 v15, s[20:23], s76 offen nt lds
    s_add_u32 s76, s76, s45
    s_mov_b32 m0, s77
    s_add_u32 s77, s77, 1024
    buffer_load_dwordx4 v15, s[20:23], s76 offen nt lds
    s_add_u32 s76, s76, s45
    s_branch L_u_mm
L_u_done:
L_head:
    v_mov_b32 v66, 6
    ds_write_b32 v196, v66
    v_lshrrev_b32 v64, 3, v1
    v_mul_u32_u24 v64, 384, v64
    v_and_b32 v65, 7, v1
    v_lshl_add_u32 v3, v65, 4, v64
    v_and_b32 v68, 1, v1
    v_lshlrev_b32 v68, 4, v68
    v_mov_b32 v67, 0xffff
    v_lshlrev_b32 v67, v68, v67
    v_lshrrev_b32 v68, 1, v65
    v_cmp_eq_u32 vcc, 0, v68
    s_nop 1
    v_cndmask_b32 v8, 0, v67, vcc
    v_cmp_eq_u32 vcc, 1, v68
    s_nop 1
    v_cndmask_b32 v9, 0, v67, vcc
    v_cmp_eq_u32 vcc, 2, v68
    s_nop 1
    v_cndmask_b32 v10, 0, v67, vcc
    v_cmp_eq_u32 vcc, 3, v68
    s_nop 1
    v_cndmask_b32 v11, 0, v67, vcc
    v_mov_b32 v24, 0
    v_mov_b32 v25, 0
    v_mov_b32 v26, 0
    v_mov_b32 v27, 0
    v_mov_b32 v28, 0
    v_mov_b32 v29, 0
    v_mov_b32 v30, 0
    v_mov_b32 v31, 0
    v_mov_b32 v32, 0
    v_mov_b32 v33, 0
    v_mov_b32 v34, 0
    v_mov_b32 v35, 0
    v_mov_b32 v5, 0xff000000
    v_mov_b32 v6, 0xff000000
    v_mov_b32 v7, 0
    s_mov_b32 s80, 0x3d93cd3a
    s_mov_b32 s81, 0x3fb8aa3b
    v_mov_b32 v202, s81
    v_lshrrev_b32 v66, 2, v1
    v_mul_u32_u24 v67, 672, v66
    v_cmp_lt_u32 vcc, 47, v1
    v_add_u32 v68, 256, v67
    v_and_b32 v69, 3, v1
    v_cndmask_b32 v67, v67, v68, vcc
    v_lshl_add_u32 v67, v69, 3, v67
    s_mul_i32 s76, s3, 160
    s_add_u32 s76, s76, 12288
    v_add_u32 v84, s76, v67
    v_add_u32 v85, 73728, v84
    v_mul_u32_u24 v66, 144, v69
    v_lshrrev_b32 v67, 4, v1
    v_lshl_add_u32 v66, v67, 3, v66
    v_add_u32 v192, 162560, v66
    v_and_b32 v64, 15, v1
    v_min_u32 v65, 2, v64
    s_mul_i32 s76, s100, 48
    s_lshr_b32 s77, s5, 1
    s_mul_i32 s77, s77, 12
    s_add_u32 s76, s76, s77
    v_lshl_add_u32 v65, v65, 2, s76
    v_lshrrev_b32 v66, 6, v65
    v_lshlrev_b32 v66, 11, v66
    v_and_b32 v65, 63, v65
    v_lshl_add_u32 v66, v65, 2, v66
    v_lshrrev_b32 v65, 5, v1
    v_mul_u32_u24 v65, 49152, v65
    v_and_b32 v68, 1, v67
    v_lshl_add_u32 v65, v68, 10, v65
    v_add_u32 v86, v65, v66
    s_mul_i32 s76, s3, 144
    s_add_u32 s76, s76, 162584
    v_lshl_add_u32 v65, v64, 4, v67
    v_lshl_add_u32 v87, v65, 1, s76
    v_and_b32 v64, 7, v1
    v_bfe_u32 v65, v1, 4, 1
    v_lshl_add_u32 v65, v64, 1, v65
    v_bfe_u32 v66, v1, 5, 1
    v_lshl_add_u32 v65, v66, 4, v65
    v_bfe_u32 v66, v1, 3, 1
    v_lshl_add_u32 v65, v66, 5, v65
    v_mul_u32_u24 v66, 43, v65
    v_lshrrev_b32 v66, 9, v66
    v_lshl_add_u32 v66, v66, 2, v65
    v_lshlrev_b32 v66, 4, v66
    v_cmp_gt_u32 vcc, 48, v65
    v_bfe_u32 v64, v65, 2, 2
    v_lshlrev_b32 v64, 8, v64
    v_and_b32 v65, 3, v65
    v_lshl_add_u32 v64, v65, 4, v64
    v_add_u32 v64, 192, v64
    v_cndmask_b32 v188, v64, v66, vcc
    v_and_b32 v64, 15, v1
    s_lshr_b32 s76, s5, 1
    s_lshl_b32 s76, s76, 8
    v_min_u32 v66, 12, v64
    v_lshl_add_u32 v66, v66, 4, s76
    v_lshrrev_b32 v67, 4, v1
    v_lshl_add_u32 v190, v67, 12, v66
    s_mul_i32 s76, s3, 144
    s_add_u32 s76, s76, 162560
    v_mul_u32_u24 v68, 43, v64
    v_lshrrev_b32 v68, 7, v68
    v_add_u32 v68, v68, v64
    v_min_u32 v68, 16, v68
    v_lshl_add_u32 v66, v68, 2, v67
    v_lshl_add_u32 v191, v66, 1, s76
    v_lshrrev_b32 v66, 2, v0
    v_mul_u32_u24 v66, 5120, v66
    v_and_b32 v68, 3, v0
    v_lshl_add_u32 v193, v68, 4, v66
    v_lshl_add_u32 v66, v67, 2, v68
    v_lshlrev_b32 v66, 2, v66
    v_add_u32 v198, 163136, v66
    v_mul_u32_u24 v66, 640, v67
    v_add_u32 v66, v66, v68
    s_lshr_b32 s76, s5, 1
    s_lshl_b32 s76, s76, 5
    s_and_b32 s77, s4, 7
    s_lshl_b32 s77, s77, 1
    s_add_u32 s76, s76, s77
    s_bfe_u32 s77, s4, 0x10003
    s_add_u32 s76, s76, s77
    s_and_b32 s77, s4, 16
    s_add_u32 s76, s76, s77
    s_lshl_b32 s76, s76, 1
    s_and_b32 s77, s5, 1
    s_or_b32 s58, s76, s77
    s_lshr_b32 s76, s58, 1
    s_lshl_b32 s76, s76, 3
    s_bitcmp0_b32 s58, 0
    s_cselect_b32 s77, 640, 0
    s_add_u32 s76, s76, s77
    v_lshl_add_u32 v199, v66, 1, s76
    buffer_load_ushort v194, v199, s[32:35], 0 offen
    s_lshl_b32 s68, s4, 15
    s_lshl_b32 s69, s3, 10
    s_add_u32 s68, s68, s69
    s_add_u32 s68, s68, 0x100000
    s_lshl_b32 s69, s5, 12
    s_add_u32 s69, s69, s68
    s_and_b32 s78, s5, 1
    s_lshl_b32 s78, s78, 7
    s_lshl_b32 s77, s4, 2
    s_add_u32 s78, s78, s77
    s_lshr_b32 s77, s5, 1
    s_add_u32 s78, s78, s77
    s_mul_i32 s78, s78, 5120
    s_mul_i32 s77, s3, 1280
    s_add_u32 s78, s78, s77
    s_add_u32 s70, s78, 0x400000
    s_bitcmp0_b32 s58, 0
    s_cselect_b32 s76, 655360, 0
    s_lshr_b32 s77, s58, 1
    s_lshl_b32 s77, s77, 6
    s_add_u32 s76, s76, s77
    s_add_u32 s71, s76, 0x400000
    s_add_u32 s55, s71, 327680
    s_lshl_b32 s76, s3, 7
    v_add_u32 v189, s76, v198
    s_lshl_b32 s76, s3, 10
    s_add_u32 s76, s76, 147456
    v_add_u32 v203, s76, v188
    v_lshrrev_b32 v64, 3, v1
    v_lshl_add_u32 v205, v64, 2, s76
    v_and_b32 v64, 0x3ff, v190
    v_add_u32 v204, s76, v64
    s_and_b32 s78, s5, 3
    s_lshl_b32 s78, s78, 4
    s_mov_b64 s[76:77], 0xffff
    s_lshl_b64 s[76:77], s[76:77], s78
    s_not_b64 s[76:77], s[76:77]
    s_cmp_lt_u32 s3, 2
    s_cselect_b64 s[76:77], -1, s[76:77]
    s_cmp_lt_u32 s5, 4
    s_cselect_b64 s[64:65], s[76:77], -1
    s_cselect_b64 s[66:67], -1, s[76:77]
    v_min_u32 v70, 47, v1
    s_mul_i32 s76, s3, 384
    s_add_u32 s76, s76, 161024
    v_lshl_add_u32 v71, v70, 3, s76
    v_lshrrev_b32 v68, 4, v70
    v_and_b32 v70, 15, v70
    v_lshlrev_b32 v70, 4, v70
    v_lshl_add_u32 v70, v68, 11, v70
    v_and_b32 v69, 7, v1
    v_lshl_add_u32 v69, v69, 4, s76
    s_mul_i32 s78, s4, 6144
    s_lshl_b32 s77, s3, 8
    s_add_u32 s78, s78, s77
    s_add_u32 s78, s78, 0x10000
    s_mov_b32 s75, 0
    s_mov_b32 s50, s3
    s_mov_b32 s51, 0
    s_mov_b32 s83, 3200000
    v_add_u32 v4, s41, v3
    ds_read_b128 v[88:91], v4 offset:0
    ds_read_b128 v[92:95], v4 offset:128
    ds_read_b128 v[96:99], v4 offset:256
    ds_read_b128 v[100:103], v4 offset:3072
    ds_read_b128 v[104:107], v4 offset:3200
    ds_read_b128 v[108:111], v4 offset:3328
    s_add_u32 s41, s41, 6144
    s_add_u32 s50, s50, 4
    v_mov_b32 v67, 7
    s_waitcnt lgkmcnt(0)
    ds_write_b32 v196, v67
L_sw1:
    ds_read_b32 v200, v195
    s_sub_u32 s83, s83, 1
    s_waitcnt lgkmcnt(0)
    v_readfirstlane_b32 s51, v200
    s_cbranch_scc1 L_sg1
    s_cmp_gt_u32 s51, s50
    s_cbranch_scc1 L_sg1
    s_sleep 2
    s_branch L_sw1
L_sg1:
    v_add_u32 v4, s41, v3
    ds_read_b128 v[112:115], v4 offset:0
    ds_read_b128 v[116:119], v4 offset:128
    ds_read_b128 v[120:123], v4 offset:256
    ds_read_b128 v[124:127], v4 offset:3072
    ds_read_b128 v[128:131], v4 offset:3200
    ds_read_b128 v[132:135], v4 offset:3328
    s_add_u32 s41, s41, 6144
    s_add_u32 s50, s50, 4
    v_mov_b32 v67, 8
    s_waitcnt lgkmcnt(0)
    ds_write_b32 v196, v67
L_sw2:
    ds_read_b32 v200, v195
    s_sub_u32 s83, s83, 1
    s_waitcnt lgkmcnt(0)
    v_readfirstlane_b32 s51, v200
    s_cbranch_scc1 L_sg2
    s_cmp_gt_u32 s51, s50
    s_cbranch_scc1 L_sg2
    s_sleep 2
    s_branch L_sw2
L_sg2:
    v_add_u32 v4, s41, v3
    ds_read_b128 v[136:139], v4 offset:0
    ds_read_b128 v[140:143], v4 offset:128
    ds_read_b128 v[144:147], v4 offset:256
    ds_read_b128 v[148:151], v4 offset:3072
    ds_read_b128 v[152:155], v4 offset:3200
    ds_read_b128 v[156:159], v4 offset:3328
    s_add_u32 s41, s41, 6144
    s_add_u32 s50, s50, 4
    v_mov_b32 v67, 9
    s_waitcnt lgkmcnt(0)
    ds_write_b32 v196, v67
L_sw3:
    ds_read_b32 v200, v195
    s_sub_u32 s83, s83, 1
    s_waitcnt lgkmcnt(0)
    v_readfirstlane_b32 s51, v200
    s_cbranch_scc1 L_sg3
    s_cmp_gt_u32 s51, s50
    s_cbranch_scc1 L_sg3
    s_sleep 2
    s_branch L_sw3
L_sg3:
    v_add_u32 v4, s41, v3
    ds_read_b128 v[36:39], v4 offset:0
    ds_read_b128 v[40:43], v4 offset:128
    ds_read_b128 v[44:47], v4 offset:256
    ds_read_b128 v[48:51], v4 offset:3072
    ds_read_b128 v[52:55], v4 offset:3200
    ds_read_b128 v[56:59], v4 offset:3328
    s_add_u32 s41, s41, 6144
    s_add_u32 s50, s50, 4
    v_mov_b32 v67, 10
    s_waitcnt lgkmcnt(0)
    ds_write_b32 v196, v67
    s_mov_b32 s75, 4
    s_mov_b32 s43, 3
    s_lshr_b32 s79, s4, 0
    s_lshr_b32 s76, s4, 2
    s_add_u32 s76, s76, s4
    s_and_b32 s76, s76, 7
    s_mov_b32 s77, s5
    s_cmp_eq_u32 s76, s77
    s_cselect_b32 s77, 0x202000, 0
    s_or_b32 s77, s77, 0x1010000
    s_cmp_eq_u32 s3, 0
    s_cselect_b32 s49, s77, 0
    s_or_b32 s48, s49, 0x1011100
    s_lshl_b32 s79, s79, 4
    s_add_u32 s56, s79, 0x1000
    s_mov_b32 s57, 0x1000
    s_mov_b32 s52, 0
    s_getreg_b32 s76, hwreg(HW_REG_XCC_ID, 0, 4)
    s_add_u32 s76, s76, 1
    v_cvt_f32_u32 v207, s76
    s_and_b32 s76, s3, 1
    s_lshl_b32 s77, s76, 10
    s_add_u32 s77, s77, 152832
    v_add_u32 v184, s77, v2
    s_lshl_b32 s76, s76, 2
    s_add_u32 s77, s76, 163696
    v_mov_b32 v185, s77
    s_add_u32 s77, s76, 163712
    v_mov_b32 v187, s77
    s_mov_b32 s83, 400000
    s_mov_b64 s[60:61], -1
    s_mov_b64 s[62:63], -1
L_qld:
    s_mov_b64 exec, s[60:61]
    s_cbranch_execz L_ql0
    buffer_load_dwordx4 v[164:167], v70, s[16:19], s78 offen offset:0 sc1
L_ql0:
    s_mov_b64 exec, s[62:63]
    s_cbranch_execz L_ql1
    buffer_load_dwordx4 v[168:171], v70, s[16:19], s78 offen offset:1024 sc1
L_ql1:
    s_waitcnt vmcnt(0)
    s_mov_b64 exec, s[60:61]
    v_xor_b32 v164, v164, v72
    v_xor_b32 v165, v165, v73
    v_xor_b32 v166, v166, v74
    v_xor_b32 v167, v167, v75
    v_or3_b32 v64, v164, v165, v166
    v_or_b32 v64, v64, v167
    v_cmp_ne_u32_sdwa s[60:61], v64, 0 src0_sel:BYTE_0 src1_sel:DWORD
    s_mov_b64 exec, s[62:63]
    v_xor_b32 v168, v168, v72
    v_xor_b32 v169, v169, v73
    v_xor_b32 v170, v170, v74
    v_xor_b32 v171, v171, v75
    v_or3_b32 v64, v168, v169, v170
    v_or_b32 v64, v64, v171
    v_cmp_ne_u32_sdwa s[62:63], v64, 0 src0_sel:BYTE_0 src1_sel:DWORD
    s_mov_b64 exec, -1
    s_or_b64 vcc, s[60:61], s[62:63]
    s_cbranch_scc0 L_qok
    s_sleep 4
    s_sub_u32 s83, s83, 1
    s_and_b32 s79, s83, 31
    s_cbranch_scc1 L_rlq
    s_waitcnt vmcnt(0)
    buffer_wbl2 sc1
    s_waitcnt vmcnt(0)
    buffer_inv sc1
    s_waitcnt vmcnt(0)
L_rlq:
    s_cmp_gt_i32 s83, 0
    s_cbranch_scc1 L_qld
L_qok:
    v_add_f32 v164, v164, v168
    v_add_f32 v165, v165, v169
    v_add_f32 v166, v166, v170
    v_add_f32 v167, v167, v171
    v_cvt_pk_bf16_f32 v64, v164, v165
    v_cvt_pk_bf16_f32 v65, v166, v167
    ds_write_b64 v71, v[64:65]
    s_and_b32 s76, s3, 2
    s_mul_i32 s76, s76, 384
    v_subrev_u32 v186, s76, v69
    s_waitcnt lgkmcnt(0)
    s_mov_b64 exec, 1
    ds_add_u32 v195, v197 offset:8
    s_mov_b64 exec, -1
    s_add_u32 s74, s74, 4
    s_mov_b32 s83, 3200000
L_bar2:
    ds_read_b32 v200, v195 offset:8
    s_sub_u32 s83, s83, 1
    s_waitcnt lgkmcnt(0)
    v_readfirstlane_b32 s79, v200
    s_cbranch_scc1 L_bard2
    s_cmp_lt_u32 s79, s74
    s_cbranch_scc1 L_bar2
L_bard2:
    ds_read_b128 v[12:15], v186 offset:0
    ds_read_b128 v[16:19], v186 offset:128
    ds_read_b128 v[20:23], v186 offset:256
    s_mov_b32 s83, 3200000
    s_waitcnt lgkmcnt(0)
    v_add_u32 v206, 96, v205
    s_branch L_kk
L_top:
    s_cmp_lg_u32 s43, 0
    s_cbranch_scc1 L_unstash
    s_cmp_eq_u32 s75, 32
    s_cbranch_scc1 L_tail
    s_bitcmp1_b32 s48, s75
    s_cbranch_scc1 L_evt
L_ffn_done:
    s_cmp_gt_u32 s51, s50
    s_cbranch_scc1 L_cons
L_wait:
    ds_read_b32 v200, v195
    s_sub_u32 s83, s83, 1
    s_cbranch_scc1 L_tail
    s_waitcnt lgkmcnt(0)
    v_readfirstlane_b32 s51, v200
    s_cmp_gt_u32 s51, s50
    s_cbranch_scc1 L_cons
    s_cmp_eq_u32 s75, 31
    s_cbranch_scc1 L_wait
    s_sleep 4
    s_branch L_wait
L_cons:
    s_and_b32 s76, s75, 15
    s_lshl_b32 s76, s76, 5
    v_add_u32 v206, s76, v205
    v_add_u32 v4, s41, v3
    ds_read_b32 v66, v206
    ds_read_b128 v[36:39], v4 offset:0
    ds_read_b128 v[40:43], v4 offset:128
    ds_read_b128 v[44:47], v4 offset:256
    ds_read_b128 v[48:51], v4 offset:3072
    ds_read_b128 v[52:55], v4 offset:3200
    ds_read_b128 v[56:59], v4 offset:3328
    s_add_u32 s41, s41, 6144
    s_cmp_eq_u32 s41, s42
    s_cselect_b32 s41, s40, s41
    s_add_u32 s75, s75, 1
    s_add_u32 s50, s50, 4
    s_add_u32 s76, s75, 6
    v_mov_b32 v67, s76
    s_cmp_gt_u32 s75, 16
    s_cbranch_scc1 L_vv
L_kk:
    s_waitcnt lgkmcnt(5)
    v_dot2_f32_bf16 v68, v36, v12, 0
    v_dot2_f32_bf16 v69, v37, v13, 0
    v_dot2_f32_bf16 v68, v38, v14, v68
    v_dot2_f32_bf16 v69, v39, v15, v69
    s_waitcnt lgkmcnt(4)
    v_dot2_f32_bf16 v68, v40, v16, v68
    v_dot2_f32_bf16 v69, v41, v17, v69
    v_dot2_f32_bf16 v68, v42, v18, v68
    v_dot2_f32_bf16 v69, v43, v19, v69
    s_waitcnt lgkmcnt(3)
    v_dot2_f32_bf16 v68, v44, v20, v68
    v_dot2_f32_bf16 v69, v45, v21, v69
    v_dot2_f32_bf16 v68, v46, v22, v68
    v_dot2_f32_bf16 v69, v47, v23, v69
    s_waitcnt lgkmcnt(2)
    v_dot2_f32_bf16 v70, v48, v12, 0
    v_dot2_f32_bf16 v71, v49, v13, 0
    v_dot2_f32_bf16 v70, v50, v14, v70
    v_dot2_f32_bf16 v71, v51, v15, v71
    s_waitcnt lgkmcnt(1)
    v_dot2_f32_bf16 v70, v52, v16, v70
    v_dot2_f32_bf16 v71, v53, v17, v71
    v_dot2_f32_bf16 v70, v54, v18, v70
    v_dot2_f32_bf16 v71, v55, v19, v71
    s_waitcnt lgkmcnt(0)
    v_dot2_f32_bf16 v70, v56, v20, v70
    v_dot2_f32_bf16 v71, v57, v21, v71
    v_dot2_f32_bf16 v70, v58, v22, v70
    v_dot2_f32_bf16 v71, v59, v23, v71
    ds_write_b32 v196, v67
    v_add_f32 v64, v68, v69
    s_nop 0
    v_add_f32 v65, v70, v71
    s_nop 0
    v_add_f32_dpp v64, v64, v64 quad_perm:[1,0,3,2] row_mask:0xf bank_mask:0xf
    v_add_f32_dpp v65, v65, v65 quad_perm:[1,0,3,2] row_mask:0xf bank_mask:0xf
    s_nop 0
    v_add_f32_dpp v64, v64, v64 quad_perm:[2,3,0,1] row_mask:0xf bank_mask:0xf
    v_add_f32_dpp v65, v65, v65 quad_perm:[2,3,0,1] row_mask:0xf bank_mask:0xf
    s_nop 0
    v_add_f32_dpp v64, v64, v64 row_half_mirror row_mask:0xf bank_mask:0xf
    v_add_f32_dpp v65, v65, v65 row_half_mirror row_mask:0xf bank_mask:0xf
    v_cvt_pk_bf16_f32 v66, v64, v65
    v_lshlrev_b32 v64, 16, v66
    v_and_b32 v65, 0xffff0000, v66
    v_mul_f32 v64, s80, v64
    v_mul_f32 v65, s80, v65
    v_cvt_pk_bf16_f32 v66, v64, v65
    ds_write_b32 v206, v66
    v_lshlrev_b32 v64, 16, v66
    v_and_b32 v65, 0xffff0000, v66
    v_max3_f32 v5, v5, v64, v65
    s_waitcnt lgkmcnt(0)
    s_branch L_top
L_vv:
    s_waitcnt lgkmcnt(6)
    v_lshlrev_b32 v64, 16, v66
    v_and_b32 v65, 0xffff0000, v66
    v_fma_f32 v64, v64, s81, -v6
    v_fma_f32 v65, v65, s81, -v6
    v_exp_f32 v64, v64
    v_exp_f32 v65, v65
    v_cvt_pk_bf16_f32 v68, v64, v64
    v_cvt_pk_bf16_f32 v69, v65, v65
    v_and_b32 v60, v68, v8
    v_and_b32 v61, v68, v9
    v_and_b32 v62, v68, v10
    v_and_b32 v63, v68, v11
    v_and_b32 v180, v69, v8
    v_and_b32 v181, v69, v9
    v_and_b32 v182, v69, v10
    v_and_b32 v183, v69, v11
    v_add_f32 v7, v7, v64
    s_waitcnt lgkmcnt(3)
    v_mfma_f32_16x16x32_bf16 v[24:27], v[60:63], v[36:39], v[24:27]
    v_mfma_f32_16x16x32_bf16 v[28:31], v[60:63], v[40:43], v[28:31]
    v_mfma_f32_16x16x32_bf16 v[32:35], v[60:63], v[44:47], v[32:35]
    v_add_f32 v7, v7, v65
    s_waitcnt lgkmcnt(0)
    v_mfma_f32_16x16x32_bf16 v[24:27], v[180:183], v[48:51], v[24:27]
    v_mfma_f32_16x16x32_bf16 v[28:31], v[180:183], v[52:55], v[28:31]
    v_mfma_f32_16x16x32_bf16 v[32:35], v[180:183], v[56:59], v[32:35]
    ds_write_b32 v196, v67
    s_branch L_top
L_unstash:
    s_sub_u32 s43, s43, 1
    s_cmp_lg_u32 s43, 0
    s_cbranch_scc1 L_us1
    v_mov_b32 v36, v88
    v_mov_b32 v37, v89
    v_mov_b32 v38, v90
    v_mov_b32 v39, v91
    v_mov_b32 v40, v92
    v_mov_b32 v41, v93
    v_mov_b32 v42, v94
    v_mov_b32 v43, v95
    v_mov_b32 v44, v96
    v_mov_b32 v45, v97
    v_mov_b32 v46, v98
    v_mov_b32 v47, v99
    v_mov_b32 v48, v100
    v_mov_b32 v49, v101
    v_mov_b32 v50, v102
    v_mov_b32 v51, v103
    v_mov_b32 v52, v104
    v_mov_b32 v53, v105
    v_mov_b32 v54, v106
    v_mov_b32 v55, v107
    v_mov_b32 v56, v108
    v_mov_b32 v57, v109
    v_mov_b32 v58, v110
    v_mov_b32 v59, v111
    v_add_u32 v206, 0, v205
    s_branch L_kk
L_us1:
    s_cmp_lg_u32 s43, 1
    s_cbranch_scc1 L_us2
    v_mov_b32 v36, v112
    v_mov_b32 v37, v113
    v_mov_b32 v38, v114
    v_mov_b32 v39, v115
    v_mov_b32 v40, v116
    v_mov_b32 v41, v117
    v_mov_b32 v42, v118
    v_mov_b32 v43, v119
    v_mov_b32 v44, v120
    v_mov_b32 v45, v121
    v_mov_b32 v46, v122
    v_mov_b32 v47, v123
    v_mov_b32 v48, v124
    v_mov_b32 v49, v125
    v_mov_b32 v50, v126
    v_mov_b32 v51, v127
    v_mov_b32 v52, v128
    v_mov_b32 v53, v129
    v_mov_b32 v54, v130
    v_mov_b32 v55, v131
    v_mov_b32 v56, v132
    v_mov_b32 v57, v133
    v_mov_b32 v58, v134
    v_mov_b32 v59, v135
    v_add_u32 v206, 32, v205
    s_branch L_kk
L_us2:
    v_mov_b32 v36, v136
    v_mov_b32 v37, v137
    v_mov_b32 v38, v138
    v_mov_b32 v39, v139
    v_mov_b32 v40, v140
    v_mov_b32 v41, v141
    v_mov_b32 v42, v142
    v_mov_b32 v43, v143
    v_mov_b32 v44, v144
    v_mov_b32 v45, v145
    v_mov_b32 v46, v146
    v_mov_b32 v47, v147
    v_mov_b32 v48, v148
    v_mov_b32 v49, v149
    v_mov_b32 v50, v150
    v_mov_b32 v51, v151
    v_mov_b32 v52, v152
    v_mov_b32 v53, v153
    v_mov_b32 v54, v154
    v_mov_b32 v55, v155
    v_mov_b32 v56, v156
    v_mov_b32 v57, v157
    v_mov_b32 v58, v158
    v_mov_b32 v59, v159
    v_add_u32 v206, 64, v205
    s_branch L_kk
L_evt:
    s_bitcmp1_b32 s49, s75
    s_cbranch_scc1 L_ctl
L_evt2:
    s_cmp_eq_u32 s75, 12
    s_cbranch_scc1 L_ffn
    s_cmp_eq_u32 s75, 24
    s_cbranch_scc1 L_fin
    s_and_b32 s76, s75, 7
    s_cbranch_scc1 L_ffn_done
    v_max_f32_dpp v5, v5, v5 row_ror:8 row_mask:0xf bank_mask:0xf
    v_mov_b32 v65, v5
    s_nop 1
    v_permlane16_swap_b32 v5, v65
    v_max_f32 v5, v5, v65
    v_mov_b32 v65, v5
    s_nop 1
    v_permlane32_swap_b32 v5, v65
    v_max_f32 v5, v5, v65
    s_lshl_b32 s76, s75, 1
    s_add_u32 s76, s76, 32
    v_add_u32 v65, s76, v196
    ds_write_b32 v65, v5
    s_cmp_eq_u32 s75, 16
    s_cbranch_scc1 L_kh
    v_mov_b32 v5, 0xff000000
    ds_read_b128 v[12:15], v186 offset:768
    ds_read_b128 v[16:19], v186 offset:896
    ds_read_b128 v[20:23], v186 offset:1024
    s_waitcnt lgkmcnt(0)
    s_branch L_ffn_done
L_kh:
L_pma:
    ds_read2_b32 v[200:201], v187 offset0:0 offset1:2
    s_sub_u32 s83, s83, 1
    s_waitcnt lgkmcnt(0)
    v_max_u32 v64, v200, v201
    s_cbranch_scc1 L_pna
    v_cmp_eq_u32 vcc, -1, v64
    s_cbranch_vccnz L_pma
L_pna:
    v_max_f32 v5, v200, v201
    v_mul_f32 v6, s81, v5
    s_branch L_ffn_done
L_ctl:
    s_mov_b32 s76, 0x1010000
    s_bitcmp1_b32 s76, s75
    s_cbranch_scc1 L_avg
    ds_read_b32 v164, v195 offset:40
    ds_read_b32 v166, v195 offset:44
    v_mov_b32 v165, s7
    v_mov_b32 v167, s7
    s_waitcnt lgkmcnt(0)
    s_mov_b64 exec, 1
    buffer_store_dwordx4 v[164:167], v2, s[16:19], s56 offen sc1
    s_mov_b64 exec, -1
    s_add_u32 s56, s56, 1024
    s_branch L_evt2
L_avg:
    v_and_b32 v168, 511, v2
    buffer_load_dwordx4 v[164:167], v168, s[16:19], s57 offen sc1
    s_memrealtime s[78:79]
    s_add_u32 s57, s57, 1024
    s_sub_u32 s77, 35, s75
    s_lshl_b32 s77, s77, 2
    s_waitcnt vmcnt(0) lgkmcnt(0)
    v_xor_b32 v165, s7, v165
    v_xor_b32 v167, s7, v167
    v_or_b32 v165, v165, v167
    v_cmp_eq_u32 vcc, 0, v165
    s_cbranch_vccz L_evt2
    v_subrev_u32 v164, s78, v164
    v_cvt_f32_i32 v164, v164
    v_cvt_f32_u32 v166, v166
    v_cndmask_b32 v164, 0, v164, vcc
    v_cndmask_b32 v166, 0, v166, vcc
    s_bcnt1_i32_b64 s76, vcc
    s_nop 1
    v_add_f32_dpp v164, v164, v164 quad_perm:[1,0,3,2] row_mask:0xf bank_mask:0xf
    s_nop 1
    v_add_f32_dpp v164, v164, v164 quad_perm:[2,3,0,1] row_mask:0xf bank_mask:0xf
    s_nop 1
    v_add_f32_dpp v164, v164, v164 row_half_mirror row_mask:0xf bank_mask:0xf
    s_nop 1
    v_add_f32_dpp v164, v164, v164 row_mirror row_mask:0xf bank_mask:0xf
    v_mov_b32 v165, v164
    s_nop 1
    v_permlane16_swap_b32 v164, v165
    v_add_f32 v164, v164, v165
    v_mov_b32 v165, v164
    s_nop 1
    v_permlane32_swap_b32 v164, v165
    v_add_f32 v164, v164, v165
    s_nop 1
    v_add_f32_dpp v166, v166, v166 quad_perm:[1,0,3,2] row_mask:0xf bank_mask:0xf
    s_nop 1
    v_add_f32_dpp v166, v166, v166 quad_perm:[2,3,0,1] row_mask:0xf bank_mask:0xf
    s_nop 1
    v_add_f32_dpp v166, v166, v166 row_half_mirror row_mask:0xf bank_mask:0xf
    s_nop 1
    v_add_f32_dpp v166, v166, v166 row_mirror row_mask:0xf bank_mask:0xf
    v_mov_b32 v165, v166
    s_nop 1
    v_permlane16_swap_b32 v166, v165
    v_add_f32 v166, v166, v165
    v_mov_b32 v165, v166
    s_nop 1
    v_permlane32_swap_b32 v166, v165
    v_add_f32 v166, v166, v165
    v_cvt_f32_u32 v165, s76
    v_rcp_f32 v165, v165
    v_cvt_f32_u32 v167, s77
    v_mul_f32 v164, v164, v165
    v_mul_f32 v166, v166, v165
    v_mul_f32 v167, 0x3c800000, v167
    v_fmac_f32 v164, v167, v166
    v_cvt_i32_f32 v164, v164
    v_cvt_u32_f32 v165, v166
    v_add_u32 v164, s78, v164
    ds_write_b64 v195, v[164:165] offset:32
    s_waitcnt lgkmcnt(0)
    s_branch L_evt2
L_ffn:
    s_lshl_b32 s76, s3, 8
    s_add_u32 s76, s76, 0x40000
    s_mov_b32 s77, 400000
L_gld:
    buffer_load_dwordx4 v[164:167], v86, s[16:19], s76 offen sc1
    s_sub_u32 s77, s77, 1
    s_waitcnt vmcnt(0)
    v_xor_b32 v164, v164, v72
    v_xor_b32 v165, v165, v73
    v_xor_b32 v166, v166, v74
    v_xor_b32 v167, v167, v75
    v_or3_b32 v64, v164, v165, v166
    v_or_b32 v64, v64, v167
    v_and_b32 v64, 0xff, v64
    v_cmp_ne_u32 vcc, 0, v64
    s_cbranch_vccz L_gok
    s_sleep 4
    s_cmp_lg_u32 s77, 0
    s_cbranch_scc1 L_gld
L_gok:
    v_permlane16_swap_b32 v164, v165
    v_permlane16_swap_b32 v166, v167
    v_add_f32 v164, v164, v165
    v_add_f32 v165, v166, v167
    s_nop 1
    v_permlane32_swap_b32 v164, v165
    v_cvt_pk_bf16_f32 v166, v164, v165
    v_lshlrev_b32 v164, 16, v166
    v_and_b32 v165, 0xffff0000, v166
    v_mul_f32 v166, v164, v164
    v_mul_f32 v166, v166, v164
    v_mov_b32 v167, v164
    v_fmac_f32 v167, 0x3d372713, v166
    v_mul_f32 v167, 0xc0135761, v167
    v_exp_f32 v167, v167
    s_nop 0
    v_add_f32 v167, 1.0, v167
    v_rcp_f32 v167, v167
    s_nop 0
    v_mul_f32 v167, v164, v167
    v_cvt_pk_bf16_f32 v167, v167, v167
    v_and_b32 v167, 0xffff0000, v167
    v_mul_f32 v167, v167, v165
    v_cvt_pk_bf16_f32 v167, v167, v167
    s_mov_b32 exec_lo, 0x00080008
    s_mov_b32 exec_hi, 0x00080008
    v_mov_b32 v167, 0
    s_mov_b32 exec_lo, 0x000f000f
    s_mov_b32 exec_hi, 0x000f000f
    ds_write_b16 v87, v167
    s_mov_b64 exec, -1
    s_waitcnt lgkmcnt(0)
    s_branch L_ffn_done
L_tail:
    s_mov_b32 s52, 1
    s_mov_b32 s54, 0
    s_cmp_ge_u32 s3, 2
    s_cbranch_scc1 L_fin
    s_add_u32 s77, s68, 16384
    s_mov_b64 exec, s[64:65]
    buffer_load_dwordx4 v[172:175], v190, s[16:19], s68 offen sc1
    s_mov_b64 exec, s[66:67]
    buffer_load_dwordx4 v[176:179], v190, s[16:19], s77 offen sc1
    s_mov_b64 exec, -1
L_fin:
    ds_read_b32 v200, v185
    ds_read_b128 v[164:167], v184
    v_add_f32_dpp v64, v7, v7 row_ror:8 row_mask:0xf bank_mask:0xf
    v_mul_f32 v65, 0x3e800000, v5
    v_mov_b32 v68, v64
    v_mul_f32 v66, 0x3e800000, v207
    v_permlane32_swap_b32 v24, v28
    v_permlane16_swap_b32 v64, v68
    v_add_f32 v64, v64, v68
    v_permlane32_swap_b32 v25, v29
    v_permlane32_swap_b32 v26, v30
    v_permlane32_swap_b32 v27, v31
    v_permlane32_swap_b32 v32, v64
    v_permlane32_swap_b32 v33, v65
    v_permlane32_swap_b32 v34, v66
    v_permlane32_swap_b32 v35, v67
    v_add_f32_dpp v24, v28, v24 row_ror:8 row_mask:0xf bank_mask:0x3
    v_add_f32_dpp v25, v29, v25 row_ror:8 row_mask:0xf bank_mask:0x3
    v_add_f32_dpp v26, v30, v26 row_ror:8 row_mask:0xf bank_mask:0x3
    v_add_f32_dpp v27, v31, v27 row_ror:8 row_mask:0xf bank_mask:0x3
    v_add_f32_dpp v24, v32, v64 row_ror:8 row_mask:0xf bank_mask:0xc
    v_add_f32_dpp v25, v33, v65 row_ror:8 row_mask:0xf bank_mask:0xc
    v_add_f32_dpp v26, v34, v66 row_ror:8 row_mask:0xf bank_mask:0xc
    v_add_f32_dpp v27, v35, v67 row_ror:8 row_mask:0xf bank_mask:0xc
    s_cmp_ge_u32 s3, 2
    s_cbranch_scc1 L_fm
    s_add_u32 s76, s52, 1
    v_mov_b32 v68, s76
    ds_write_b128 v184, v[24:27]
    ds_write_b32 v185, v68
    s_waitcnt vmcnt(0)
    s_branch L_fj
L_fr:
    ds_read_b32 v200, v185
    ds_read_b128 v[164:167], v184
L_fm:
    s_sub_u32 s83, s83, 1
    s_waitcnt lgkmcnt(0)
    v_cmp_ge_u32 vcc, s52, v200
    s_cbranch_scc1 L_fx
    s_cbranch_vccnz L_fr
L_fx:
    s_cmp_eq_u32 s52, 0
    s_cselect_b32 s76, 2048, 0
    s_sub_u32 s76, s69, s76
    v_add_f32 v24, v24, v164
    v_add_f32 v25, v25, v165
    v_add_f32 v26, v26, v166
    v_add_f32 v27, v27, v167
    v_bfi_b32 v28, s82, v72, v24
    v_bfi_b32 v29, s82, v73, v25
    v_bfi_b32 v30, s82, v74, v26
    v_bfi_b32 v31, s82, v75, v27
    buffer_store_dwordx4 v[28:31], v188, s[16:19], s76 offen
    s_cmp_eq_u32 s52, 0
    s_cbranch_scc1 L_fj
    v_xor_b32 v24, v28, v72
    v_xor_b32 v25, v29, v73
    v_xor_b32 v26, v30, v74
    v_xor_b32 v27, v31, v75
    ds_write_b128 v203, v[24:27]
    s_not_b64 exec, s[64:65]
    ds_read_b128 v[172:175], v204
    s_not_b64 exec, s[66:67]
    ds_read_b128 v[176:179], v204
    s_sleep 4
    s_add_u32 s77, s68, 16384
    s_mov_b64 exec, s[64:65]
    buffer_load_dwordx4 v[172:175], v190, s[16:19], s68 offen sc1
    s_mov_b64 exec, s[66:67]
    buffer_load_dwordx4 v[176:179], v190, s[16:19], s77 offen sc1
    s_mov_b64 exec, -1
    s_mov_b32 s54, 0
    s_cmp_lg_u32 s54, 0
    s_cbranch_scc1 L_mbg
    s_mov_b64 exec, -1
    ds_read_b32 v200, v195 offset:4
    s_waitcnt lgkmcnt(0)
    v_readfirstlane_b32 s54, v200
    s_cmp_eq_u32 s54, 0
    s_cbranch_scc1 L_mbg
    ds_read_b64_tr_b16 v[88:89], v84 offset:0
    ds_read_b64_tr_b16 v[90:91], v84 offset:36864
    ds_read_b64_tr_b16 v[92:93], v85 offset:0
    ds_read_b64_tr_b16 v[94:95], v85 offset:36864
    ds_read_b64_tr_b16 v[96:97], v84 offset:32
    ds_read_b64_tr_b16 v[98:99], v84 offset:36896
    ds_read_b64_tr_b16 v[100:101], v85 offset:32
    ds_read_b64_tr_b16 v[102:103], v85 offset:36896
    ds_read_b64_tr_b16 v[104:105], v84 offset:64
    ds_read_b64_tr_b16 v[106:107], v84 offset:36928
    ds_read_b64_tr_b16 v[108:109], v85 offset:64
    ds_read_b64_tr_b16 v[110:111], v85 offset:36928
    s_waitcnt lgkmcnt(6)
    ds_read_b64_tr_b16 v[112:113], v84 offset:96
    ds_read_b64_tr_b16 v[114:115], v84 offset:36960
    ds_read_b64_tr_b16 v[116:117], v85 offset:96
    ds_read_b64_tr_b16 v[118:119], v85 offset:36960
    ds_read_b64_tr_b16 v[120:121], v84 offset:128
    ds_read_b64_tr_b16 v[122:123], v84 offset:36992
    ds_read_b64_tr_b16 v[124:125], v85 offset:128
    ds_read_b64_tr_b16 v[126:127], v85 offset:36992
L_mbg:
    s_waitcnt vmcnt(0)
L_fj:
    s_mov_b64 exec, -1
    s_cmp_lg_u32 s52, 0
    s_cbranch_scc1 L_hop
    s_waitcnt lgkmcnt(0)
    v_add_u32 v184, 2048, v184
    v_mov_b32 v24, 0
    v_mov_b32 v25, 0
    v_mov_b32 v26, 0
    v_mov_b32 v27, 0
    v_mov_b32 v28, 0
    v_mov_b32 v29, 0
    v_mov_b32 v30, 0
    v_mov_b32 v31, 0
    v_mov_b32 v32, 0
    v_mov_b32 v33, 0
    v_mov_b32 v34, 0
    v_mov_b32 v35, 0
    v_mov_b32 v7, 0
L_pmb:
    ds_read2_b32 v[200:201], v187 offset0:4 offset1:6
    s_sub_u32 s83, s83, 1
    s_waitcnt lgkmcnt(0)
    v_max_u32 v64, v200, v201
    s_cbranch_scc1 L_pnb
    v_cmp_eq_u32 vcc, -1, v64
    s_cbranch_vccnz L_pmb
L_pnb:
    v_max_f32 v5, v200, v201
    v_mul_f32 v6, s81, v5
    s_branch L_ffn_done
L_hop:
    s_mov_b32 s83, 400000
    s_add_u32 s77, s68, 16384
    s_sub_u32 s83, s83, 1
    s_waitcnt vmcnt(1) lgkmcnt(0)
    s_branch L_op_d
L_op:
    s_and_b32 s79, s83, 31
    s_cbranch_scc1 L_rlo
    s_waitcnt vmcnt(0)
    buffer_wbl2 sc1
    s_waitcnt vmcnt(0)
    buffer_inv sc1
    s_waitcnt vmcnt(0)
L_rlo:
    s_mov_b64 exec, s[64:65]
    s_cbranch_execz L_op_l0
    buffer_load_dwordx4 v[172:175], v190, s[16:19], s68 offen sc1
L_op_l0:
    s_mov_b64 exec, s[66:67]
    s_cbranch_execz L_op_l1
    buffer_load_dwordx4 v[176:179], v190, s[16:19], s77 offen sc1
L_op_l1:
    s_sub_u32 s83, s83, 1
    s_cbranch_scc1 L_op_x
    s_cmp_lg_u32 s54, 0
    s_cbranch_scc1 L_mbop
    s_mov_b64 exec, -1
    ds_read_b32 v200, v195 offset:4
    s_waitcnt lgkmcnt(0)
    v_readfirstlane_b32 s54, v200
    s_cmp_eq_u32 s54, 0
    s_cbranch_scc1 L_mbop
    ds_read_b64_tr_b16 v[88:89], v84 offset:0
    ds_read_b64_tr_b16 v[90:91], v84 offset:36864
    ds_read_b64_tr_b16 v[92:93], v85 offset:0
    ds_read_b64_tr_b16 v[94:95], v85 offset:36864
    ds_read_b64_tr_b16 v[96:97], v84 offset:32
    ds_read_b64_tr_b16 v[98:99], v84 offset:36896
    ds_read_b64_tr_b16 v[100:101], v85 offset:32
    ds_read_b64_tr_b16 v[102:103], v85 offset:36896
    ds_read_b64_tr_b16 v[104:105], v84 offset:64
    ds_read_b64_tr_b16 v[106:107], v84 offset:36928
    ds_read_b64_tr_b16 v[108:109], v85 offset:64
    ds_read_b64_tr_b16 v[110:111], v85 offset:36928
    s_waitcnt lgkmcnt(6)
    ds_read_b64_tr_b16 v[112:113], v84 offset:96
    ds_read_b64_tr_b16 v[114:115], v84 offset:36960
    ds_read_b64_tr_b16 v[116:117], v85 offset:96
    ds_read_b64_tr_b16 v[118:119], v85 offset:36960
    ds_read_b64_tr_b16 v[120:121], v84 offset:128
    ds_read_b64_tr_b16 v[122:123], v84 offset:36992
    ds_read_b64_tr_b16 v[124:125], v85 offset:128
    ds_read_b64_tr_b16 v[126:127], v85 offset:36992
L_mbop:
    s_waitcnt vmcnt(0)
L_op_d:
    s_mov_b64 exec, s[64:65]
    s_cbranch_execz L_op_c0
    v_xor_b32 v172, v172, v72
    v_xor_b32 v173, v173, v73
    v_xor_b32 v174, v174, v74
    v_xor_b32 v175, v175, v75
    v_or3_b32 v64, v172, v173, v174
    v_or_b32 v64, v64, v175
    v_cmp_ne_u32_sdwa s[64:65], v64, 0 src0_sel:BYTE_0 src1_sel:DWORD
L_op_c0:
    s_mov_b64 exec, s[66:67]
    s_cbranch_execz L_op_c1
    v_xor_b32 v176, v176, v72
    v_xor_b32 v177, v177, v73
    v_xor_b32 v178, v178, v74
    v_xor_b32 v179, v179, v75
    v_or3_b32 v64, v176, v177, v178
    v_or_b32 v64, v64, v179
    v_cmp_ne_u32_sdwa s[66:67], v64, 0 src0_sel:BYTE_0 src1_sel:DWORD
L_op_c1:
    s_or_b64 vcc, s[64:65], s[66:67]
    s_cbranch_scc1 L_op
L_op_x:
    s_mov_b64 exec, -1
    v_cmp_neq_f32 vcc, v174, v207
    v_cmp_neq_f32 s[78:79], v178, v207
    v_mul_f32_dpp v64, v173, v202 row_newbcast:12 row_mask:0xf bank_mask:0xf
    v_mul_f32_dpp v65, v177, v202 row_newbcast:12 row_mask:0xf bank_mask:0xf
    v_max_f32 v66, v64, v65
    v_max_f32 v67, v64, v65
    s_nop 1
    v_permlane16_swap_b32 v66, v67
    v_max_f32 v68, v66, v67
    v_max_f32 v66, v66, v67
    s_nop 1
    v_permlane32_swap_b32 v66, v68
    v_max_f32 v66, v66, v68
    v_sub_f32 v64, v64, v66
    v_sub_f32 v65, v65, v66
    v_exp_f32 v64, v64
    v_exp_f32 v65, v65
    v_mul_f32 v172, v172, v64
    v_mul_f32 v173, v173, v64
    v_mul_f32 v174, v174, v64
    v_mul_f32 v175, v175, v64
    v_fmac_f32 v172, v176, v65
    v_fmac_f32 v174, v178, v65
    v_fmac_f32 v173, v177, v65
    v_fmac_f32 v175, v179, v65
    v_permlane32_swap_b32 v172, v174
    v_add_f32 v172, v172, v174
    v_permlane32_swap_b32 v173, v175
    v_add_f32 v173, v173, v175
    s_nop 1
    v_permlane16_swap_b32 v172, v173
    v_add_f32 v172, v172, v173
    s_nop 0
    v_readlane_b32 s76, v172, 12
    s_nop 1
    v_rcp_f32 v64, s76
    s_nop 0
    v_mul_f32 v172, v172, v64
    v_cvt_pk_bf16_f32 v172, v172, v172
    ds_write_b16 v191, v172
    s_or_b64 vcc, vcc, s[78:79]
    s_or_b32 s76, vcc_lo, vcc_hi
    s_and_b32 s76, s76, 0x10001000
    s_cbranch_scc0 L_onedie
    s_waitcnt vmcnt(0)
    buffer_wbl2 sc1
    s_waitcnt vmcnt(0)
L_onedie:
    s_cmp_ge_u32 s3, 2
    s_cbranch_scc1 L_bw_x
L_bw:
    s_cmp_lg_u32 s54, 0
    s_cbranch_scc1 L_mbw
    s_mov_b64 exec, -1
    ds_read_b32 v200, v195 offset:4
    s_waitcnt lgkmcnt(0)
    v_readfirstlane_b32 s54, v200
    s_cmp_eq_u32 s54, 0
    s_cbranch_scc1 L_mbw
    ds_read_b64_tr_b16 v[88:89], v84 offset:0
    ds_read_b64_tr_b16 v[90:91], v84 offset:36864
    ds_read_b64_tr_b16 v[92:93], v85 offset:0
    ds_read_b64_tr_b16 v[94:95], v85 offset:36864
    ds_read_b64_tr_b16 v[96:97], v84 offset:32
    ds_read_b64_tr_b16 v[98:99], v84 offset:36896
    ds_read_b64_tr_b16 v[100:101], v85 offset:32
    ds_read_b64_tr_b16 v[102:103], v85 offset:36896
    ds_read_b64_tr_b16 v[104:105], v84 offset:64
    ds_read_b64_tr_b16 v[106:107], v84 offset:36928
    ds_read_b64_tr_b16 v[108:109], v85 offset:64
    ds_read_b64_tr_b16 v[110:111], v85 offset:36928
    s_waitcnt lgkmcnt(6)
    ds_read_b64_tr_b16 v[112:113], v84 offset:96
    ds_read_b64_tr_b16 v[114:115], v84 offset:36960
    ds_read_b64_tr_b16 v[116:117], v85 offset:96
    ds_read_b64_tr_b16 v[118:119], v85 offset:36960
    ds_read_b64_tr_b16 v[120:121], v84 offset:128
    ds_read_b64_tr_b16 v[122:123], v84 offset:36992
    ds_read_b64_tr_b16 v[124:125], v85 offset:128
    ds_read_b64_tr_b16 v[126:127], v85 offset:36992
L_mbw:
    s_sub_u32 s83, s83, 1
    s_cbranch_scc1 L_bw_x
    s_cmp_eq_u32 s54, 0
    s_cbranch_scc1 L_bw
L_bw_x:
    s_waitcnt lgkmcnt(0)
    s_barrier
    ds_read2_b64 v[60:63], v192 offset0:0 offset1:4
    ds_read2_b64 v[64:67], v192 offset0:8 offset1:12
    s_cmp_lg_u32 s54, 0
    s_cbranch_scc1 L_bdone
    ds_read_b64_tr_b16 v[88:89], v84 offset:0
    ds_read_b64_tr_b16 v[90:91], v84 offset:36864
    ds_read_b64_tr_b16 v[92:93], v85 offset:0
    ds_read_b64_tr_b16 v[94:95], v85 offset:36864
    ds_read_b64_tr_b16 v[96:97], v84 offset:32
    ds_read_b64_tr_b16 v[98:99], v84 offset:36896
    ds_read_b64_tr_b16 v[100:101], v85 offset:32
    ds_read_b64_tr_b16 v[102:103], v85 offset:36896
    ds_read_b64_tr_b16 v[104:105], v84 offset:64
    ds_read_b64_tr_b16 v[106:107], v84 offset:36928
    ds_read_b64_tr_b16 v[108:109], v85 offset:64
    ds_read_b64_tr_b16 v[110:111], v85 offset:36928
    s_waitcnt lgkmcnt(6)
    ds_read_b64_tr_b16 v[112:113], v84 offset:96
    ds_read_b64_tr_b16 v[114:115], v84 offset:36960
    ds_read_b64_tr_b16 v[116:117], v85 offset:96
    ds_read_b64_tr_b16 v[118:119], v85 offset:36960
    ds_read_b64_tr_b16 v[120:121], v84 offset:128
    ds_read_b64_tr_b16 v[122:123], v84 offset:36992
    ds_read_b64_tr_b16 v[124:125], v85 offset:128
    ds_read_b64_tr_b16 v[126:127], v85 offset:36992
L_bdone:
    s_waitcnt lgkmcnt(0)
    v_mfma_f32_16x16x32_bf16 v[148:151], v[60:63], v[88:91], 0
    v_mfma_f32_16x16x32_bf16 v[148:151], v[64:67], v[92:95], v[148:151]
    v_mfma_f32_16x16x32_bf16 v[152:155], v[60:63], v[96:99], 0
    v_mfma_f32_16x16x32_bf16 v[152:155], v[64:67], v[100:103], v[152:155]
    v_mfma_f32_16x16x32_bf16 v[156:159], v[60:63], v[104:107], 0
    v_mfma_f32_16x16x32_bf16 v[156:159], v[64:67], v[108:111], v[156:159]
    v_mfma_f32_16x16x32_bf16 v[160:163], v[60:63], v[112:115], 0
    v_mfma_f32_16x16x32_bf16 v[160:163], v[64:67], v[116:119], v[160:163]
    v_mfma_f32_16x16x32_bf16 v[164:167], v[60:63], v[120:123], 0
    v_mfma_f32_16x16x32_bf16 v[164:167], v[64:67], v[124:127], v[164:167]
    s_nop 1
    v_mov_b32_dpp v148, v152 quad_perm:[0,1,2,3] row_mask:0x2 bank_mask:0xf
    v_mov_b32_dpp v149, v153 quad_perm:[0,1,2,3] row_mask:0x2 bank_mask:0xf
    v_mov_b32_dpp v150, v154 quad_perm:[0,1,2,3] row_mask:0x2 bank_mask:0xf
    v_mov_b32_dpp v151, v155 quad_perm:[0,1,2,3] row_mask:0x2 bank_mask:0xf
    v_mov_b32_dpp v148, v156 quad_perm:[0,1,2,3] row_mask:0x4 bank_mask:0xf
    v_mov_b32_dpp v149, v157 quad_perm:[0,1,2,3] row_mask:0x4 bank_mask:0xf
    v_mov_b32_dpp v150, v158 quad_perm:[0,1,2,3] row_mask:0x4 bank_mask:0xf
    v_mov_b32_dpp v151, v159 quad_perm:[0,1,2,3] row_mask:0x4 bank_mask:0xf
    v_mov_b32_dpp v148, v160 quad_perm:[0,1,2,3] row_mask:0x8 bank_mask:0xf
    v_mov_b32_dpp v149, v161 quad_perm:[0,1,2,3] row_mask:0x8 bank_mask:0xf
    v_mov_b32_dpp v150, v162 quad_perm:[0,1,2,3] row_mask:0x8 bank_mask:0xf
    v_mov_b32_dpp v151, v163 quad_perm:[0,1,2,3] row_mask:0x8 bank_mask:0xf
    v_bfi_b32 v148, s82, v72, v148
    v_bfi_b32 v149, s82, v73, v149
    v_bfi_b32 v150, s82, v74, v150
    v_bfi_b32 v151, s82, v75, v151
    buffer_store_dwordx4 v[148:151], v2, s[16:19], s70 offen sc1
    s_mov_b64 exec, 0xffff
    v_bfi_b32 v164, s82, v72, v164
    v_bfi_b32 v165, s82, v73, v165
    v_bfi_b32 v166, s82, v74, v166
    v_bfi_b32 v167, s82, v75, v167
    buffer_store_dwordx4 v[164:167], v2, s[16:19], s70 offen offset:1024 sc1
    s_mov_b64 exec, -1
    s_cmp_ge_u32 s58, 160
    s_cbranch_scc1 L_done
    s_sleep 20
    s_mov_b64 s[64:65], -1
    buffer_load_dwordx4 v[36:39], v193, s[16:19], s71 offen sc1
    s_mov_b64 s[66:67], -1
    buffer_load_dwordx4 v[40:43], v193, s[16:19], s55 offen sc1
    s_mov_b32 s83, 399999
    s_waitcnt vmcnt(0) lgkmcnt(0)
    s_branch L_fi_d
L_fi:
    s_mov_b64 exec, s[64:65]
    s_cbranch_execz L_fi_l0
    buffer_load_dwordx4 v[36:39], v193, s[16:19], s71 offen sc1
L_fi_l0:
    s_mov_b64 exec, s[66:67]
    s_cbranch_execz L_fi_l1
    buffer_load_dwordx4 v[40:43], v193, s[16:19], s55 offen sc1
L_fi_l1:
    s_sub_u32 s83, s83, 1
    s_cbranch_scc1 L_fi_x
    s_waitcnt vmcnt(0)
L_fi_d:
    s_mov_b64 exec, s[64:65]
    s_cbranch_execz L_fi_c0
    v_xor_b32 v36, v36, v72
    v_xor_b32 v37, v37, v73
    v_xor_b32 v38, v38, v74
    v_xor_b32 v39, v39, v75
    v_or3_b32 v64, v36, v37, v38
    v_or_b32 v64, v64, v39
    v_cmp_ne_u32_sdwa s[64:65], v64, 0 src0_sel:BYTE_0 src1_sel:DWORD
L_fi_c0:
    s_mov_b64 exec, s[66:67]
    s_cbranch_execz L_fi_c1
    v_xor_b32 v40, v40, v72
    v_xor_b32 v41, v41, v73
    v_xor_b32 v42, v42, v74
    v_xor_b32 v43, v43, v75
    v_or3_b32 v64, v40, v41, v42
    v_or_b32 v64, v64, v43
    v_cmp_ne_u32_sdwa s[66:67], v64, 0 src0_sel:BYTE_0 src1_sel:DWORD
L_fi_c1:
    s_or_b64 vcc, s[64:65], s[66:67]
    s_cbranch_scc1 L_fi
L_fi_x:
    s_mov_b64 exec, -1
    v_add_f32 v36, v36, v40
    v_add_f32 v38, v38, v42
    v_add_f32 v37, v37, v41
    v_add_f32 v39, v39, v43
    v_permlane32_swap_b32 v36, v38
    v_add_f32 v36, v36, v38
    v_permlane32_swap_b32 v37, v39
    v_add_f32 v37, v37, v39
    s_nop 1
    v_permlane16_swap_b32 v36, v37
    v_add_f32 v36, v36, v37
    s_nop 1
    v_add_f32_dpp v36, v36, v36 row_ror:8 row_mask:0xf bank_mask:0xf
    s_nop 1
    v_add_f32_dpp v36, v36, v36 row_ror:4 row_mask:0xf bank_mask:0xf
    ds_write_b32 v189, v36
    s_waitcnt lgkmcnt(0)
    s_barrier
    s_cmp_eq_u32 s3, 0
    s_cbranch_scc1 L_out
    s_lshl_b32 s76, s2, 2
    s_add_u32 s76, s76, s3
    s_cmp_lg_u32 s76, 1
    s_cbranch_scc1 L_done
    v_mov_b32 v64, s7
    v_mov_b32 v65, 0
    s_mov_b64 exec, 1
    buffer_store_dword v64, v65, s[16:19], 0 offen sc1
    s_mov_b64 exec, -1
    s_branch L_done
L_out:
    ds_read_b32 v36, v198 offset:0
    ds_read_b32 v37, v198 offset:128
    ds_read_b32 v38, v198 offset:256
    ds_read_b32 v39, v198 offset:384
    v_lshlrev_b32 v194, 16, v194
    s_waitcnt lgkmcnt(0)
    v_add_f32 v36, v36, v37
    v_add_f32 v38, v38, v39
    v_add_f32 v36, v36, v38
    v_add_f32 v36, v194, v36
    s_nop 1
    v_mov_b32_dpp v37, v36 quad_perm:[1,1,3,3] row_mask:0xf bank_mask:0xf
    v_cvt_pk_bf16_f32 v38, v36, v37
    s_nop 1
    v_mov_b32_dpp v39, v38 quad_perm:[2,2,2,2] row_mask:0xf bank_mask:0xf
    s_mov_b32 exec_lo, 0x00010001
    s_mov_b32 exec_hi, 0x00010001
    buffer_store_dwordx2 v[38:39], v199, s[36:39], 0 offen sc1
    s_mov_b64 exec, -1
L_done:
L_end:
    s_endpgm
L_loader:
    s_setprio 3
    s_mov_b64 s[72:73], s[52:53]
    s_mov_b32 s59, 4
    v_mov_b32 v36, 0
    v_mov_b32 v40, 4
    v_mov_b32 v44, -1
    v_mov_b32 v37, 0
    v_mov_b32 v41, 4
    v_mov_b32 v45, -1
    v_mov_b32 v38, 0
    v_mov_b32 v42, 4
    v_mov_b32 v46, -1
    v_mov_b32 v39, 0
    v_mov_b32 v43, 4
    v_mov_b32 v47, -1
    ds_write_b128 v195, v[36:39] offset:0
    ds_write_b128 v195, v[40:43] offset:16
    ds_write_b128 v195, v[36:39] offset:32
    ds_write_b128 v195, v[36:39] offset:48
    ds_write_b128 v195, v[44:47] offset:64
    ds_write_b128 v195, v[44:47] offset:80
    s_mul_i32 s76, s5, 3072
    s_add_u32 s64, s76, 98304
    s_add_u32 s65, s76, 100761600
    s_add_u32 s66, s76, 147456
    s_add_u32 s67, s76, 100810752
    s_mov_b32 s48, 0x1212100
    s_mov_b32 s75, 1
    s_mov_b32 s60, 6144
    s_mov_b32 s58, 4
    s_mov_b32 s51, 0
    s_mov_b32 s61, 0
    s_mov_b32 s53, 0
    s_mov_b32 s68, 0
    s_mov_b32 s83, 3200000
    v_mov_b32 v67, 0x7ffffff0
    v_add_u32 v68, 0, v1
    v_mul_u32_u24 v69, 49933, v68
    v_lshrrev_b32 v69, 21, v69
    v_mul_u32_u24 v70, 42, v69
    v_sub_u32 v70, v68, v70
    v_cmp_gt_u32 vcc, 40, v70
    v_cmp_gt_u32 s[76:77], 12, v69
    v_mul_u32_u24 v69, 1280, v69
    v_lshl_add_u32 v69, v70, 4, v69
    s_and_b64 vcc, vcc, s[76:77]
    v_cndmask_b32 v76, v67, v69, vcc
    v_add_u32 v68, 64, v1
    v_mul_u32_u24 v69, 49933, v68
    v_lshrrev_b32 v69, 21, v69
    v_mul_u32_u24 v70, 42, v69
    v_sub_u32 v70, v68, v70
    v_cmp_gt_u32 vcc, 40, v70
    v_cmp_gt_u32 s[76:77], 12, v69
    v_mul_u32_u24 v69, 1280, v69
    v_lshl_add_u32 v69, v70, 4, v69
    s_and_b64 vcc, vcc, s[76:77]
    v_cndmask_b32 v77, v67, v69, vcc
    v_add_u32 v68, 128, v1
    v_mul_u32_u24 v69, 49933, v68
    v_lshrrev_b32 v69, 21, v69
    v_mul_u32_u24 v70, 42, v69
    v_sub_u32 v70, v68, v70
    v_cmp_gt_u32 vcc, 40, v70
    v_cmp_gt_u32 s[76:77], 12, v69
    v_mul_u32_u24 v69, 1280, v69
    v_lshl_add_u32 v69, v70, 4, v69
    s_and_b64 vcc, vcc, s[76:77]
    v_cndmask_b32 v78, v67, v69, vcc
    v_add_u32 v68, 192, v1
    v_mul_u32_u24 v69, 49933, v68
    v_lshrrev_b32 v69, 21, v69
    v_mul_u32_u24 v70, 42, v69
    v_sub_u32 v70, v68, v70
    v_cmp_gt_u32 vcc, 40, v70
    v_cmp_gt_u32 s[76:77], 12, v69
    v_mul_u32_u24 v69, 1280, v69
    v_lshl_add_u32 v69, v70, 4, v69
    s_and_b64 vcc, vcc, s[76:77]
    v_cndmask_b32 v79, v67, v69, vcc
    v_add_u32 v68, 256, v1
    v_mul_u32_u24 v69, 49933, v68
    v_lshrrev_b32 v69, 21, v69
    v_mul_u32_u24 v70, 42, v69
    v_sub_u32 v70, v68, v70
    v_cmp_gt_u32 vcc, 40, v70
    v_cmp_gt_u32 s[76:77], 12, v69
    v_mul_u32_u24 v69, 1280, v69
    v_lshl_add_u32 v69, v70, 4, v69
    s_and_b64 vcc, vcc, s[76:77]
    v_cndmask_b32 v80, v67, v69, vcc
    v_add_u32 v68, 320, v1
    v_mul_u32_u24 v69, 49933, v68
    v_lshrrev_b32 v69, 21, v69
    v_mul_u32_u24 v70, 42, v69
    v_sub_u32 v70, v68, v70
    v_cmp_gt_u32 vcc, 40, v70
    v_cmp_gt_u32 s[76:77], 12, v69
    v_mul_u32_u24 v69, 1280, v69
    v_lshl_add_u32 v69, v70, 4, v69
    s_and_b64 vcc, vcc, s[76:77]
    v_cndmask_b32 v81, v67, v69, vcc
    v_add_u32 v68, 384, v1
    v_mul_u32_u24 v69, 49933, v68
    v_lshrrev_b32 v69, 21, v69
    v_mul_u32_u24 v70, 42, v69
    v_sub_u32 v70, v68, v70
    v_cmp_gt_u32 vcc, 40, v70
    v_cmp_gt_u32 s[76:77], 12, v69
    v_mul_u32_u24 v69, 1280, v69
    v_lshl_add_u32 v69, v70, 4, v69
    s_and_b64 vcc, vcc, s[76:77]
    v_cndmask_b32 v82, v67, v69, vcc
    v_add_u32 v68, 448, v1
    v_mul_u32_u24 v69, 49933, v68
    v_lshrrev_b32 v69, 21, v69
    v_mul_u32_u24 v70, 42, v69
    v_sub_u32 v70, v68, v70
    v_cmp_gt_u32 vcc, 40, v70
    v_cmp_gt_u32 s[76:77], 12, v69
    v_mul_u32_u24 v69, 1280, v69
    v_lshl_add_u32 v69, v70, 4, v69
    s_and_b64 vcc, vcc, s[76:77]
    v_cndmask_b32 v83, v67, v69, vcc
    v_add_u32 v68, 34, v1
    v_mul_u32_u24 v69, 49933, v68
    v_lshrrev_b32 v69, 21, v69
    v_mul_u32_u24 v70, 42, v69
    v_sub_u32 v70, v68, v70
    v_subrev_u32 v69, 1, v69
    v_cmp_gt_u32 vcc, 40, v70
    v_cmp_gt_u32 s[76:77], 4, v69
    v_mul_u32_u24 v69, 1280, v69
    v_lshl_add_u32 v69, v70, 4, v69
    s_and_b64 vcc, vcc, s[76:77]
    v_cndmask_b32 v84, v67, v69, vcc
    v_add_u32 v68, 98, v1
    v_mul_u32_u24 v69, 49933, v68
    v_lshrrev_b32 v69, 21, v69
    v_mul_u32_u24 v70, 42, v69
    v_sub_u32 v70, v68, v70
    v_subrev_u32 v69, 1, v69
    v_cmp_gt_u32 vcc, 40, v70
    v_cmp_gt_u32 s[76:77], 4, v69
    v_mul_u32_u24 v69, 1280, v69
    v_lshl_add_u32 v69, v70, 4, v69
    s_and_b64 vcc, vcc, s[76:77]
    v_cndmask_b32 v85, v67, v69, vcc
    v_add_u32 v68, 162, v1
    v_mul_u32_u24 v69, 49933, v68
    v_lshrrev_b32 v69, 21, v69
    v_mul_u32_u24 v70, 42, v69
    v_sub_u32 v70, v68, v70
    v_subrev_u32 v69, 1, v69
    v_cmp_gt_u32 vcc, 40, v70
    v_cmp_gt_u32 s[76:77], 4, v69
    v_mul_u32_u24 v69, 1280, v69
    v_lshl_add_u32 v69, v70, 4, v69
    s_and_b64 vcc, vcc, s[76:77]
    v_cndmask_b32 v86, v67, v69, vcc
    s_waitcnt lgkmcnt(0)
    s_barrier
    s_mov_b32 s62, 320
    s_mov_b32 s49, -1
    s_branch L_ld_top
L_ld_w0:
    s_add_u32 m0, s60, 0
    s_sub_u32 s71, s58, 3
    s_waitcnt vmcnt(19)
    buffer_load_dwordx4 v2, s[8:11], s64 offen offset:0 nt lds
    buffer_load_dwordx4 v2, s[8:11], s64 offen offset:1024 nt lds
    buffer_load_dwordx4 v2, s[8:11], s64 offen offset:2048 nt lds
    s_add_u32 m0, s60, 3072
    s_add_u32 s58, s58, 1
    s_waitcnt vmcnt(19)
    buffer_load_dwordx4 v2, s[12:15], s64 offen offset:0 nt lds
    buffer_load_dwordx4 v2, s[12:15], s64 offen offset:1024 nt lds
    buffer_load_dwordx4 v2, s[12:15], s64 offen offset:2048 nt lds
    s_max_i32 s51, s51, s71
    v_mov_b32 v64, s51
    ds_write_b32 v195, v64
    s_add_u32 s64, s64, 98304
    s_add_u32 m0, s60, 36864
    s_sub_u32 s71, s58, 3
    s_waitcnt vmcnt(19)
    buffer_load_dwordx4 v2, s[8:11], s65 offen offset:0 nt lds
    buffer_load_dwordx4 v2, s[8:11], s65 offen offset:1024 nt lds
    buffer_load_dwordx4 v2, s[8:11], s65 offen offset:2048 nt lds
    s_add_u32 m0, s60, 39936
    s_add_u32 s58, s58, 1
    s_waitcnt vmcnt(19)
    buffer_load_dwordx4 v2, s[12:15], s65 offen offset:0 nt lds
    buffer_load_dwordx4 v2, s[12:15], s65 offen offset:1024 nt lds
    buffer_load_dwordx4 v2, s[12:15], s65 offen offset:2048 nt lds
    s_max_i32 s51, s51, s71
    v_mov_b32 v64, s51
    ds_write_b32 v195, v64
    s_add_u32 s65, s65, 98304
    s_add_u32 m0, s60, 73728
    s_sub_u32 s71, s58, 3
    s_waitcnt vmcnt(19)
    buffer_load_dwordx4 v2, s[8:11], s66 offen offset:0 nt lds
    buffer_load_dwordx4 v2, s[8:11], s66 offen offset:1024 nt lds
    buffer_load_dwordx4 v2, s[8:11], s66 offen offset:2048 nt lds
    s_add_u32 m0, s60, 76800
    s_add_u32 s58, s58, 1
    s_waitcnt vmcnt(19)
    buffer_load_dwordx4 v2, s[12:15], s66 offen offset:0 nt lds
    buffer_load_dwordx4 v2, s[12:15], s66 offen offset:1024 nt lds
    buffer_load_dwordx4 v2, s[12:15], s66 offen offset:2048 nt lds
    s_max_i32 s51, s51, s71
    v_mov_b32 v64, s51
    ds_write_b32 v195, v64
    s_add_u32 s66, s66, 98304
    s_add_u32 m0, s60, 110592
    s_sub_u32 s71, s58, 3
    ds_read_b128 v[40:43], v195 offset:16
    ds_read_b64 v[44:45], v195 offset:32
    s_memrealtime s[68:69]
    s_waitcnt vmcnt(19)
    buffer_load_dwordx4 v2, s[8:11], s67 offen offset:0 nt lds
    buffer_load_dwordx4 v2, s[8:11], s67 offen offset:1024 nt lds
    buffer_load_dwordx4 v2, s[8:11], s67 offen offset:2048 nt lds
    s_add_u32 m0, s60, 113664
    s_waitcnt lgkmcnt(0)
    v_min_u32 v40, v40, v41
    v_min3_u32 v40, v40, v42, v43
    v_readfirstlane_b32 s70, v44
    v_readfirstlane_b32 s61, v45
    v_readfirstlane_b32 s59, v40
    s_add_u32 s58, s58, 1
    s_add_u32 s75, s75, 1
    s_add_u32 s60, s60, 6144
    s_cmp_eq_u32 s60, 36864
    s_cselect_b32 s60, 0, s60
    s_sub_u32 s76, s68, s70
    s_lshl_b32 s76, s76, 4
    s_sub_u32 s77, 32, s75
    s_mul_i32 s77, s77, s61
    s_add_u32 s76, s76, s77
    s_cmp_eq_u32 s61, 0
    s_cselect_b32 s62, 320, s76
    s_waitcnt vmcnt(19)
    buffer_load_dwordx4 v2, s[12:15], s67 offen offset:0 nt lds
    buffer_load_dwordx4 v2, s[12:15], s67 offen offset:1024 nt lds
    buffer_load_dwordx4 v2, s[12:15], s67 offen offset:2048 nt lds
    s_max_i32 s51, s51, s71
    v_mov_b32 v64, s51
    ds_write_b32 v195, v64
    s_add_u32 s67, s67, 98304
L_ld_top:
    s_cmp_le_u32 s59, s75
    s_cbranch_scc1 L_ld_full
L_ld_room:
    s_bitcmp1_b64 s[48:49], s75
    s_cbranch_scc1 L_ld_evt
L_ld_ctl:
    s_cmp_gt_i32 s62, 480
    s_cbranch_scc1 L_ld_up
    s_cmp_lt_i32 s62, 80
    s_cbranch_scc1 L_ld_w1
    s_branch L_ld_w0
L_ld_full:
    s_cmp_gt_u32 s59, s75
    s_cbranch_scc1 L_ld_rgo
L_ld_rchk:
    ds_read_b128 v[36:39], v195 offset:16
    s_waitcnt lgkmcnt(0)
    v_min_u32 v36, v36, v37
    v_min3_u32 v36, v36, v38, v39
    s_nop 0
    v_readfirstlane_b32 s59, v36
    s_sub_u32 s83, s83, 1
    s_cbranch_scc1 L_ld_rgo
    s_cmp_gt_u32 s59, s75
    s_cbranch_scc1 L_ld_rgo
    s_waitcnt vmcnt(0)
    s_lshl_b32 s76, s75, 2
    s_max_i32 s51, s51, s76
    v_mov_b32 v64, s51
    ds_write_b32 v195, v64
    s_sleep 1
    s_branch L_ld_rchk
L_ld_rgo:
    s_branch L_ld_room
L_ld_up:
    s_cmp_gt_i32 s62, 1440
    s_cbranch_scc1 L_ld_w4
    s_cmp_gt_i32 s62, 880
    s_cbranch_scc1 L_ld_w3
L_ld_w2:
    s_add_u32 m0, s60, 0
    s_sub_u32 s71, s58, 4
    s_waitcnt vmcnt(22)
    buffer_load_dwordx4 v2, s[8:11], s64 offen offset:0 nt lds
    buffer_load_dwordx4 v2, s[8:11], s64 offen offset:1024 nt lds
    buffer_load_dwordx4 v2, s[8:11], s64 offen offset:2048 nt lds
    s_add_u32 m0, s60, 3072
    s_max_i32 s51, s51, s71
    v_mov_b32 v64, s51
    ds_write_b32 v195, v64
    s_add_u32 s58, s58, 1
    s_waitcnt vmcnt(22)
    buffer_load_dwordx4 v2, s[12:15], s64 offen offset:0 nt lds
    buffer_load_dwordx4 v2, s[12:15], s64 offen offset:1024 nt lds
    buffer_load_dwordx4 v2, s[12:15], s64 offen offset:2048 nt lds
    s_add_u32 s64, s64, 98304
    s_add_u32 m0, s60, 36864
    s_sub_u32 s71, s58, 4
    s_waitcnt vmcnt(22)
    buffer_load_dwordx4 v2, s[8:11], s65 offen offset:0 nt lds
    buffer_load_dwordx4 v2, s[8:11], s65 offen offset:1024 nt lds
    buffer_load_dwordx4 v2, s[8:11], s65 offen offset:2048 nt lds
    s_add_u32 m0, s60, 39936
    s_max_i32 s51, s51, s71
    v_mov_b32 v64, s51
    ds_write_b32 v195, v64
    s_add_u32 s58, s58, 1
    s_waitcnt vmcnt(22)
    buffer_load_dwordx4 v2, s[12:15], s65 offen offset:0 nt lds
    buffer_load_dwordx4 v2, s[12:15], s65 offen offset:1024 nt lds
    buffer_load_dwordx4 v2, s[12:15], s65 offen offset:2048 nt lds
    s_add_u32 s65, s65, 98304
    s_add_u32 m0, s60, 73728
    s_sub_u32 s71, s58, 4
    s_waitcnt vmcnt(22)
    buffer_load_dwordx4 v2, s[8:11], s66 offen offset:0 nt lds
    buffer_load_dwordx4 v2, s[8:11], s66 offen offset:1024 nt lds
    buffer_load_dwordx4 v2, s[8:11], s66 offen offset:2048 nt lds
    s_add_u32 m0, s60, 76800
    s_max_i32 s51, s51, s71
    v_mov_b32 v64, s51
    ds_write_b32 v195, v64
    s_add_u32 s58, s58, 1
    s_waitcnt vmcnt(22)
    buffer_load_dwordx4 v2, s[12:15], s66 offen offset:0 nt lds
    buffer_load_dwordx4 v2, s[12:15], s66 offen offset:1024 nt lds
    buffer_load_dwordx4 v2, s[12:15], s66 offen offset:2048 nt lds
    s_add_u32 s66, s66, 98304
    s_add_u32 m0, s60, 110592
    s_sub_u32 s71, s58, 4
    ds_read_b128 v[40:43], v195 offset:16
    ds_read_b64 v[44:45], v195 offset:32
    s_memrealtime s[68:69]
    s_waitcnt vmcnt(22)
    buffer_load_dwordx4 v2, s[8:11], s67 offen offset:0 nt lds
    buffer_load_dwordx4 v2, s[8:11], s67 offen offset:1024 nt lds
    buffer_load_dwordx4 v2, s[8:11], s67 offen offset:2048 nt lds
    s_add_u32 m0, s60, 113664
    s_waitcnt lgkmcnt(0)
    v_min_u32 v40, v40, v41
    v_min3_u32 v40, v40, v42, v43
    v_readfirstlane_b32 s70, v44
    v_readfirstlane_b32 s61, v45
    v_readfirstlane_b32 s59, v40
    s_max_i32 s51, s51, s71
    v_mov_b32 v64, s51
    ds_write_b32 v195, v64
    s_add_u32 s58, s58, 1
    s_add_u32 s75, s75, 1
    s_add_u32 s60, s60, 6144
    s_cmp_eq_u32 s60, 36864
    s_cselect_b32 s60, 0, s60
    s_sub_u32 s76, s68, s70
    s_lshl_b32 s76, s76, 4
    s_sub_u32 s77, 32, s75
    s_mul_i32 s77, s77, s61
    s_add_u32 s76, s76, s77
    s_cmp_eq_u32 s61, 0
    s_cselect_b32 s62, 320, s76
    s_waitcnt vmcnt(22)
    buffer_load_dwordx4 v2, s[12:15], s67 offen offset:0 nt lds
    buffer_load_dwordx4 v2, s[12:15], s67 offen offset:1024 nt lds
    buffer_load_dwordx4 v2, s[12:15], s67 offen offset:2048 nt lds
    s_add_u32 s67, s67, 98304
    s_branch L_ld_top
L_ld_w3:
    s_add_u32 m0, s60, 0
    s_sub_u32 s71, s58, 4
    s_waitcnt vmcnt(27)
    buffer_load_dwordx4 v2, s[8:11], s64 offen offset:0 nt lds
    buffer_load_dwordx4 v2, s[8:11], s64 offen offset:1024 nt lds
    buffer_load_dwordx4 v2, s[8:11], s64 offen offset:2048 nt lds
    s_add_u32 m0, s60, 3072
    s_add_u32 s58, s58, 1
    s_waitcnt vmcnt(27)
    buffer_load_dwordx4 v2, s[12:15], s64 offen offset:0 nt lds
    buffer_load_dwordx4 v2, s[12:15], s64 offen offset:1024 nt lds
    buffer_load_dwordx4 v2, s[12:15], s64 offen offset:2048 nt lds
    s_max_i32 s51, s51, s71
    v_mov_b32 v64, s51
    ds_write_b32 v195, v64
    s_add_u32 s64, s64, 98304
    s_add_u32 m0, s60, 36864
    s_sub_u32 s71, s58, 4
    s_waitcnt vmcnt(27)
    buffer_load_dwordx4 v2, s[8:11], s65 offen offset:0 nt lds
    buffer_load_dwordx4 v2, s[8:11], s65 offen offset:1024 nt lds
    buffer_load_dwordx4 v2, s[8:11], s65 offen offset:2048 nt lds
    s_add_u32 m0, s60, 39936
    s_add_u32 s58, s58, 1
    s_waitcnt vmcnt(27)
    buffer_load_dwordx4 v2, s[12:15], s65 offen offset:0 nt lds
    buffer_load_dwordx4 v2, s[12:15], s65 offen offset:1024 nt lds
    buffer_load_dwordx4 v2, s[12:15], s65 offen offset:2048 nt lds
    s_max_i32 s51, s51, s71
    v_mov_b32 v64, s51
    ds_write_b32 v195, v64
    s_add_u32 s65, s65, 98304
    s_add_u32 m0, s60, 73728
    s_sub_u32 s71, s58, 4
    s_waitcnt vmcnt(27)
    buffer_load_dwordx4 v2, s[8:11], s66 offen offset:0 nt lds
    buffer_load_dwordx4 v2, s[8:11], s66 offen offset:1024 nt lds
    buffer_load_dwordx4 v2, s[8:11], s66 offen offset:2048 nt lds
    s_add_u32 m0, s60, 76800
    s_add_u32 s58, s58, 1
    s_waitcnt vmcnt(27)
    buffer_load_dwordx4 v2, s[12:15], s66 offen offset:0 nt lds
    buffer_load_dwordx4 v2, s[12:15], s66 offen offset:1024 nt lds
    buffer_load_dwordx4 v2, s[12:15], s66 offen offset:2048 nt lds
    s_max_i32 s51, s51, s71
    v_mov_b32 v64, s51
    ds_write_b32 v195, v64
    s_add_u32 s66, s66, 98304
    s_add_u32 m0, s60, 110592
    s_sub_u32 s71, s58, 4
    ds_read_b128 v[40:43], v195 offset:16
    ds_read_b64 v[44:45], v195 offset:32
    s_memrealtime s[68:69]
    s_waitcnt vmcnt(27)
    buffer_load_dwordx4 v2, s[8:11], s67 offen offset:0 nt lds
    buffer_load_dwordx4 v2, s[8:11], s67 offen offset:1024 nt lds
    buffer_load_dwordx4 v2, s[8:11], s67 offen offset:2048 nt lds
    s_add_u32 m0, s60, 113664
    s_waitcnt lgkmcnt(0)
    v_min_u32 v40, v40, v41
    v_min3_u32 v40, v40, v42, v43
    v_readfirstlane_b32 s70, v44
    v_readfirstlane_b32 s61, v45
    v_readfirstlane_b32 s59, v40
    s_add_u32 s58, s58, 1
    s_add_u32 s75, s75, 1
    s_add_u32 s60, s60, 6144
    s_cmp_eq_u32 s60, 36864
    s_cselect_b32 s60, 0, s60
    s_sub_u32 s76, s68, s70
    s_lshl_b32 s76, s76, 4
    s_sub_u32 s77, 32, s75
    s_mul_i32 s77, s77, s61
    s_add_u32 s76, s76, s77
    s_cmp_eq_u32 s61, 0
    s_cselect_b32 s62, 320, s76
    s_waitcnt vmcnt(27)
    buffer_load_dwordx4 v2, s[12:15], s67 offen offset:0 nt lds
    buffer_load_dwordx4 v2, s[12:15], s67 offen offset:1024 nt lds
    buffer_load_dwordx4 v2, s[12:15], s67 offen offset:2048 nt lds
    s_max_i32 s51, s51, s71
    v_mov_b32 v64, s51
    ds_write_b32 v195, v64
    s_add_u32 s67, s67, 98304
    s_branch L_ld_top
L_ld_w4:
    s_add_u32 m0, s60, 0
    s_sub_u32 s71, s58, 6
    s_waitcnt vmcnt(38)
    buffer_load_dwordx4 v2, s[8:11], s64 offen offset:0 nt lds
    buffer_load_dwordx4 v2, s[8:11], s64 offen offset:1024 nt lds
    buffer_load_dwordx4 v2, s[8:11], s64 offen offset:2048 nt lds
    s_add_u32 m0, s60, 3072
    s_add_u32 s58, s58, 1
    s_waitcnt vmcnt(38)
    buffer_load_dwordx4 v2, s[12:15], s64 offen offset:0 nt lds
    buffer_load_dwordx4 v2, s[12:15], s64 offen offset:1024 nt lds
    buffer_load_dwordx4 v2, s[12:15], s64 offen offset:2048 nt lds
    s_max_i32 s51, s51, s71
    v_mov_b32 v64, s51
    ds_write_b32 v195, v64
    s_add_u32 s64, s64, 98304
    s_add_u32 m0, s60, 36864
    s_sub_u32 s71, s58, 6
    s_waitcnt vmcnt(38)
    buffer_load_dwordx4 v2, s[8:11], s65 offen offset:0 nt lds
    buffer_load_dwordx4 v2, s[8:11], s65 offen offset:1024 nt lds
    buffer_load_dwordx4 v2, s[8:11], s65 offen offset:2048 nt lds
    s_add_u32 m0, s60, 39936
    s_add_u32 s58, s58, 1
    s_waitcnt vmcnt(38)
    buffer_load_dwordx4 v2, s[12:15], s65 offen offset:0 nt lds
    buffer_load_dwordx4 v2, s[12:15], s65 offen offset:1024 nt lds
    buffer_load_dwordx4 v2, s[12:15], s65 offen offset:2048 nt lds
    s_max_i32 s51, s51, s71
    v_mov_b32 v64, s51
    ds_write_b32 v195, v64
    s_add_u32 s65, s65, 98304
    s_add_u32 m0, s60, 73728
    s_sub_u32 s71, s58, 6
    s_waitcnt vmcnt(38)
    buffer_load_dwordx4 v2, s[8:11], s66 offen offset:0 nt lds
    buffer_load_dwordx4 v2, s[8:11], s66 offen offset:1024 nt lds
    buffer_load_dwordx4 v2, s[8:11], s66 offen offset:2048 nt lds
    s_add_u32 m0, s60, 76800
    s_add_u32 s58, s58, 1
    s_waitcnt vmcnt(38)
    buffer_load_dwordx4 v2, s[12:15], s66 offen offset:0 nt lds
    buffer_load_dwordx4 v2, s[12:15], s66 offen offset:1024 nt lds
    buffer_load_dwordx4 v2, s[12:15], s66 offen offset:2048 nt lds
    s_max_i32 s51, s51, s71
    v_mov_b32 v64, s51
    ds_write_b32 v195, v64
    s_add_u32 s66, s66, 98304
    s_add_u32 m0, s60, 110592
    s_sub_u32 s71, s58, 6
    ds_read_b128 v[40:43], v195 offset:16
    ds_read_b64 v[44:45], v195 offset:32
    s_memrealtime s[68:69]
    s_waitcnt vmcnt(38)
    buffer_load_dwordx4 v2, s[8:11], s67 offen offset:0 nt lds
    buffer_load_dwordx4 v2, s[8:11], s67 offen offset:1024 nt lds
    buffer_load_dwordx4 v2, s[8:11], s67 offen offset:2048 nt lds
    s_add_u32 m0, s60, 113664
    s_waitcnt lgkmcnt(0)
    v_min_u32 v40, v40, v41
    v_min3_u32 v40, v40, v42, v43
    v_readfirstlane_b32 s70, v44
    v_readfirstlane_b32 s61, v45
    v_readfirstlane_b32 s59, v40
    s_add_u32 s58, s58, 1
    s_add_u32 s75, s75, 1
    s_add_u32 s60, s60, 6144
    s_cmp_eq_u32 s60, 36864
    s_cselect_b32 s60, 0, s60
    s_sub_u32 s76, s68, s70
    s_lshl_b32 s76, s76, 4
    s_sub_u32 s77, 32, s75
    s_mul_i32 s77, s77, s61
    s_add_u32 s76, s76, s77
    s_cmp_eq_u32 s61, 0
    s_cselect_b32 s62, 320, s76
    s_waitcnt vmcnt(38)
    buffer_load_dwordx4 v2, s[12:15], s67 offen offset:0 nt lds
    buffer_load_dwordx4 v2, s[12:15], s67 offen offset:1024 nt lds
    buffer_load_dwordx4 v2, s[12:15], s67 offen offset:2048 nt lds
    s_max_i32 s51, s51, s71
    v_mov_b32 v64, s51
    ds_write_b32 v195, v64
    s_add_u32 s67, s67, 98304
    s_branch L_ld_top
L_ld_w1:
    s_add_u32 m0, s60, 0
    s_sub_u32 s71, s58, 3
    s_waitcnt vmcnt(17)
    buffer_load_dwordx4 v2, s[8:11], s64 offen offset:0 nt lds
    buffer_load_dwordx4 v2, s[8:11], s64 offen offset:1024 nt lds
    buffer_load_dwordx4 v2, s[8:11], s64 offen offset:2048 nt lds
    s_add_u32 m0, s60, 3072
    s_max_i32 s51, s51, s71
    v_mov_b32 v64, s51
    ds_write_b32 v195, v64
    s_add_u32 s58, s58, 1
    s_waitcnt vmcnt(17)
    buffer_load_dwordx4 v2, s[12:15], s64 offen offset:0 nt lds
    buffer_load_dwordx4 v2, s[12:15], s64 offen offset:1024 nt lds
    buffer_load_dwordx4 v2, s[12:15], s64 offen offset:2048 nt lds
    s_add_u32 s64, s64, 98304
    s_add_u32 m0, s60, 36864
    s_sub_u32 s71, s58, 3
    s_waitcnt vmcnt(17)
    buffer_load_dwordx4 v2, s[8:11], s65 offen offset:0 nt lds
    buffer_load_dwordx4 v2, s[8:11], s65 offen offset:1024 nt lds
    buffer_load_dwordx4 v2, s[8:11], s65 offen offset:2048 nt lds
    s_add_u32 m0, s60, 39936
    s_max_i32 s51, s51, s71
    v_mov_b32 v64, s51
    ds_write_b32 v195, v64
    s_add_u32 s58, s58, 1
    s_waitcnt vmcnt(17)
    buffer_load_dwordx4 v2, s[12:15], s65 offen offset:0 nt lds
    buffer_load_dwordx4 v2, s[12:15], s65 offen offset:1024 nt lds
    buffer_load_dwordx4 v2, s[12:15], s65 offen offset:2048 nt lds
    s_add_u32 s65, s65, 98304
    s_add_u32 m0, s60, 73728
    s_sub_u32 s71, s58, 3
    s_waitcnt vmcnt(17)
    buffer_load_dwordx4 v2, s[8:11], s66 offen offset:0 nt lds
    buffer_load_dwordx4 v2, s[8:11], s66 offen offset:1024 nt lds
    buffer_load_dwordx4 v2, s[8:11], s66 offen offset:2048 nt lds
    s_add_u32 m0, s60, 76800
    s_max_i32 s51, s51, s71
    v_mov_b32 v64, s51
    ds_write_b32 v195, v64
    s_add_u32 s58, s58, 1
    s_waitcnt vmcnt(17)
    buffer_load_dwordx4 v2, s[12:15], s66 offen offset:0 nt lds
    buffer_load_dwordx4 v2, s[12:15], s66 offen offset:1024 nt lds
    buffer_load_dwordx4 v2, s[12:15], s66 offen offset:2048 nt lds
    s_add_u32 s66, s66, 98304
    s_add_u32 m0, s60, 110592
    s_sub_u32 s71, s58, 3
    ds_read_b128 v[40:43], v195 offset:16
    ds_read_b64 v[44:45], v195 offset:32
    s_memrealtime s[68:69]
    s_waitcnt vmcnt(17)
    buffer_load_dwordx4 v2, s[8:11], s67 offen offset:0 nt lds
    buffer_load_dwordx4 v2, s[8:11], s67 offen offset:1024 nt lds
    buffer_load_dwordx4 v2, s[8:11], s67 offen offset:2048 nt lds
    s_add_u32 m0, s60, 113664
    s_waitcnt lgkmcnt(0)
    v_min_u32 v40, v40, v41
    v_min3_u32 v40, v40, v42, v43
    v_readfirstlane_b32 s70, v44
    v_readfirstlane_b32 s61, v45
    v_readfirstlane_b32 s59, v40
    s_max_i32 s51, s51, s71
    v_mov_b32 v64, s51
    ds_write_b32 v195, v64
    s_add_u32 s58, s58, 1
    s_add_u32 s75, s75, 1
    s_add_u32 s60, s60, 6144
    s_cmp_eq_u32 s60, 36864
    s_cselect_b32 s60, 0, s60
    s_sub_u32 s76, s68, s70
    s_lshl_b32 s76, s76, 4
    s_sub_u32 s77, 32, s75
    s_mul_i32 s77, s77, s61
    s_add_u32 s76, s76, s77
    s_cmp_eq_u32 s61, 0
    s_cselect_b32 s62, 320, s76
    s_waitcnt vmcnt(17)
    buffer_load_dwordx4 v2, s[12:15], s67 offen offset:0 nt lds
    buffer_load_dwordx4 v2, s[12:15], s67 offen offset:1024 nt lds
    buffer_load_dwordx4 v2, s[12:15], s67 offen offset:2048 nt lds
    s_add_u32 s67, s67, 98304
    s_branch L_ld_top
L_ld_evt:
    s_cmp_eq_u32 s75, 32
    s_cbranch_scc1 L_ld_drain
    s_cmp_lg_u32 s75, 16
    s_cbranch_scc1 L_ld_e2
    s_mov_b64 s[8:9], s[72:73]
    s_add_u32 s12, s72, 24576
    s_addc_u32 s13, s73, 0
    s_sub_u32 s64, s64, 202113024
    s_sub_u32 s65, s65, 202113024
    s_sub_u32 s66, s66, 202113024
    s_sub_u32 s67, s67, 202113024
L_ld_e2:
    s_and_b32 s76, s75, 15
    s_cmp_eq_u32 s76, 8
    s_cselect_b32 s76, 200540160, 0
    s_add_u32 s64, s64, s76
    s_add_u32 s65, s65, s76
    s_add_u32 s66, s66, s76
    s_add_u32 s67, s67, s76
    s_mov_b32 s76, 0x202100
    s_bitcmp0_b32 s76, s75
    s_cbranch_scc1 L_ld_ctl
    s_sub_u32 s77, s68, s53
    s_mov_b32 s53, s68
    s_mov_b32 s78, 0
    s_cmp_eq_u32 s75, 13
    s_cselect_b32 s78, 13107, s78
    s_cmp_eq_u32 s75, 21
    s_cselect_b32 s78, 8192, s78
    s_mul_i32 s77, s77, s78
    s_lshr_b32 s77, s77, 12
    v_mov_b32 v36, s68
    v_mov_b32 v37, s77
    ds_write_b64 v195, v[36:37] offset:40
    s_branch L_ld_ctl
L_ld_drain:
    s_mov_b32 s78, 33
    s_sub_u32 s58, s58, 6
    s_cmp_gt_u32 s59, s78
    s_cbranch_scc1 L_ld_ego
L_ld_echk:
    ds_read_b128 v[36:39], v195 offset:16
    s_waitcnt lgkmcnt(0)
    v_min_u32 v36, v36, v37
    v_min3_u32 v36, v36, v38, v39
    s_nop 0
    v_readfirstlane_b32 s59, v36
    s_sub_u32 s83, s83, 1
    s_cbranch_scc1 L_ld_ego
    s_cmp_gt_u32 s59, s78
    s_cbranch_scc1 L_ld_ego
    s_waitcnt vmcnt(0)
    s_lshl_b32 s76, s75, 2
    s_max_i32 s51, s51, s76
    v_mov_b32 v64, s51
    ds_write_b32 v195, v64
    s_sleep 1
    s_branch L_ld_echk
L_ld_ego:
    s_lshl_b32 s76, s4, 2
    s_lshr_b32 s77, s5, 1
    s_add_u32 s76, s76, s77
    s_lshl_b32 s78, s100, 2
    s_add_u32 s78, s78, s77
    s_mul_i32 s78, s78, 15360
    s_mul_i32 s76, s76, 61440
    s_and_b32 s77, s5, 1
    s_mul_i32 s77, s77, 640
    s_add_u32 s76, s76, s77
    s_add_u32 s78, s78, s77
    s_add_u32 s77, s60, 0
    s_waitcnt vmcnt(21)
    s_add_u32 s58, s58, 2
    s_max_i32 s51, s51, s58
    v_mov_b32 v64, s51
    ds_write_b32 v195, v64
    s_add_u32 s58, s58, 1
    s_mov_b32 m0, s77
    s_add_u32 s77, s77, 1024
    buffer_load_dwordx4 v76, s[24:27], s76 offen nt lds
    s_mov_b32 m0, s77
    s_add_u32 s77, s77, 1024
    buffer_load_dwordx4 v77, s[24:27], s76 offen nt lds
    s_mov_b32 m0, s77
    s_add_u32 s77, s77, 1024
    buffer_load_dwordx4 v78, s[24:27], s76 offen nt lds
    s_waitcnt vmcnt(21)
    s_max_i32 s51, s51, s58
    v_mov_b32 v64, s51
    ds_write_b32 v195, v64
    s_add_u32 s58, s58, 1
    s_mov_b32 m0, s77
    s_add_u32 s77, s77, 1024
    buffer_load_dwordx4 v79, s[24:27], s76 offen nt lds
    s_mov_b32 m0, s77
    s_add_u32 s77, s77, 1024
    buffer_load_dwordx4 v80, s[24:27], s76 offen nt lds
    s_mov_b32 m0, s77
    s_add_u32 s77, s77, 1024
    buffer_load_dwordx4 v81, s[24:27], s76 offen nt lds
    s_waitcnt vmcnt(21)
    s_mov_b32 m0, s77
    s_add_u32 s77, s77, 1024
    buffer_load_dwordx4 v82, s[24:27], s76 offen nt lds
    s_mov_b32 m0, s77
    s_add_u32 s77, s77, 1024
    buffer_load_dwordx4 v83, s[24:27], s76 offen nt lds
    s_mov_b32 m0, s77
    s_add_u32 s77, s77, 1024
    buffer_load_dwordx4 v84, s[28:31], s78 offen nt lds
    s_waitcnt vmcnt(21)
    s_max_i32 s51, s51, s58
    v_mov_b32 v64, s51
    ds_write_b32 v195, v64
    s_add_u32 s58, s58, 1
    s_mov_b32 m0, s77
    s_add_u32 s77, s77, 1024
    buffer_load_dwordx4 v85, s[28:31], s78 offen nt lds
    s_mov_b32 m0, s77
    s_add_u32 s77, s77, 26624
    buffer_load_dwordx4 v86, s[28:31], s78 offen nt lds
    s_add_u32 s76, s76, 15360
    s_add_u32 s78, s78, 5120
    s_mov_b32 m0, s77
    s_add_u32 s77, s77, 1024
    buffer_load_dwordx4 v76, s[24:27], s76 offen nt lds
    s_waitcnt vmcnt(21)
    s_mov_b32 m0, s77
    s_add_u32 s77, s77, 1024
    buffer_load_dwordx4 v77, s[24:27], s76 offen nt lds
    s_mov_b32 m0, s77
    s_add_u32 s77, s77, 1024
    buffer_load_dwordx4 v78, s[24:27], s76 offen nt lds
    s_mov_b32 m0, s77
    s_add_u32 s77, s77, 1024
    buffer_load_dwordx4 v79, s[24:27], s76 offen nt lds
    s_waitcnt vmcnt(21)
    s_max_i32 s51, s51, s58
    v_mov_b32 v64, s51
    ds_write_b32 v195, v64
    s_add_u32 s58, s58, 1
    s_mov_b32 m0, s77
    s_add_u32 s77, s77, 1024
    buffer_load_dwordx4 v80, s[24:27], s76 offen nt lds
    s_mov_b32 m0, s77
    s_add_u32 s77, s77, 1024
    buffer_load_dwordx4 v81, s[24:27], s76 offen nt lds
    s_mov_b32 m0, s77
    s_add_u32 s77, s77, 1024
    buffer_load_dwordx4 v82, s[24:27], s76 offen nt lds
    s_waitcnt vmcnt(21)
    s_mov_b32 m0, s77
    s_add_u32 s77, s77, 1024
    buffer_load_dwordx4 v83, s[24:27], s76 offen nt lds
    s_mov_b32 m0, s77
    s_add_u32 s77, s77, 1024
    buffer_load_dwordx4 v84, s[28:31], s78 offen nt lds
    s_mov_b32 m0, s77
    s_add_u32 s77, s77, 1024
    buffer_load_dwordx4 v85, s[28:31], s78 offen nt lds
    s_waitcnt vmcnt(21)
    s_max_i32 s51, s51, s58
    v_mov_b32 v64, s51
    ds_write_b32 v195, v64
    s_add_u32 s58, s58, 1
    s_mov_b32 m0, s77
    s_add_u32 s77, s77, 26624
    buffer_load_dwordx4 v86, s[28:31], s78 offen nt lds
    s_add_u32 s76, s76, 15360
    s_add_u32 s78, s78, 5120
    s_mov_b32 m0, s77
    s_add_u32 s77, s77, 1024
    buffer_load_dwordx4 v76, s[24:27], s76 offen nt lds
    s_mov_b32 m0, s77
    s_add_u32 s77, s77, 1024
    buffer_load_dwordx4 v77, s[24:27], s76 offen nt lds
    s_waitcnt vmcnt(21)
    s_mov_b32 m0, s77
    s_add_u32 s77, s77, 1024
    buffer_load_dwordx4 v78, s[24:27], s76 offen nt lds
    s_mov_b32 m0, s77
    s_add_u32 s77, s77, 1024
    buffer_load_dwordx4 v79, s[24:27], s76 offen nt lds
    s_mov_b32 m0, s77
    s_add_u32 s77, s77, 1024
    buffer_load_dwordx4 v80, s[24:27], s76 offen nt lds
    s_waitcnt vmcnt(21)
    s_mov_b32 m0, s77
    s_add_u32 s77, s77, 1024
    buffer_load_dwordx4 v81, s[24:27], s76 offen nt lds
    s_mov_b32 m0, s77
    s_add_u32 s77, s77, 1024
    buffer_load_dwordx4 v82, s[24:27], s76 offen nt lds
    s_mov_b32 m0, s77
    s_add_u32 s77, s77, 1024
    buffer_load_dwordx4 v83, s[24:27], s76 offen nt lds
    s_waitcnt vmcnt(21)
    s_mov_b32 m0, s77
    s_add_u32 s77, s77, 1024
    buffer_load_dwordx4 v84, s[28:31], s78 offen nt lds
    s_mov_b32 m0, s77
    s_add_u32 s77, s77, 1024
    buffer_load_dwordx4 v85, s[28:31], s78 offen nt lds
    s_mov_b32 m0, s77
    s_add_u32 s77, s77, 26624
    buffer_load_dwordx4 v86, s[28:31], s78 offen nt lds
    s_add_u32 s76, s76, 15360
    s_add_u32 s78, s78, 5120
    s_waitcnt vmcnt(21)
    s_mov_b32 m0, s77
    s_add_u32 s77, s77, 1024
    buffer_load_dwordx4 v76, s[24:27], s76 offen nt lds
    s_mov_b32 m0, s77
    s_add_u32 s77, s77, 1024
    buffer_load_dwordx4 v77, s[24:27], s76 offen nt lds
    s_mov_b32 m0, s77
    s_add_u32 s77, s77, 1024
    buffer_load_dwordx4 v78, s[24:27], s76 offen nt lds
    s_waitcnt vmcnt(21)
    s_mov_b32 m0, s77
    s_add_u32 s77, s77, 1024
    buffer_load_dwordx4 v79, s[24:27], s76 offen nt lds
    s_mov_b32 m0, s77
    s_add_u32 s77, s77, 1024
    buffer_load_dwordx4 v80, s[24:27], s76 offen nt lds
    s_mov_b32 m0, s77
    s_add_u32 s77, s77, 1024
    buffer_load_dwordx4 v81, s[24:27], s76 offen nt lds
    s_waitcnt vmcnt(21)
    s_mov_b32 m0, s77
    s_add_u32 s77, s77, 1024
    buffer_load_dwordx4 v82, s[24:27], s76 offen nt lds
    s_mov_b32 m0, s77
    s_add_u32 s77, s77, 1024
    buffer_load_dwordx4 v83, s[24:27], s76 offen nt lds
    s_add_u32 s76, s76, 15360
    s_add_u32 s78, s78, 5120
    v_mov_b32 v36, 0
    v_mov_b32 v37, 0
    v_mov_b32 v38, 0
    v_mov_b32 v39, 0
    v_add_u32 v66, s77, v2
    ds_write_b128 v66, v[36:39] offset:0
    ds_write_b128 v66, v[36:39] offset:1024
    ds_write_b128 v66, v[36:39] offset:2048
    s_and_b32 s78, s5, 1
    s_lshl_b32 s78, s78, 7
    s_lshl_b32 s77, s4, 2
    s_add_u32 s78, s78, s77
    s_lshr_b32 s77, s5, 1
    s_add_u32 s78, s78, s77
    s_mul_i32 s78, s78, 5120
    s_add_u32 s78, s78, 0x400000
    v_lshlrev_b32 v67, 7, v1
    s_mov_b32 exec_hi, 0xff
    s_mov_b32 exec_hi, -1
    s_waitcnt vmcnt(0) lgkmcnt(0)
    v_mov_b32 v64, 1
    ds_write_b32 v195, v64 offset:4
    s_waitcnt lgkmcnt(0)
    s_endpgm
.section .rodata,"a"
.p2align 6
.amdhsa_kernel parallel_sum__sliding_block_cached__geglu_ffn__decode_kernel
  .amdhsa_next_free_vgpr 208
  .amdhsa_next_free_sgpr 102
  .amdhsa_accum_offset 208
  .amdhsa_group_segment_fixed_size 0
  .amdhsa_kernarg_size 96
  .amdhsa_user_sgpr_count 2
  .amdhsa_user_sgpr_kernarg_segment_ptr 1
  .amdhsa_system_sgpr_workgroup_id_x 1
  .amdhsa_float_denorm_mode_32 3
  .amdhsa_float_denorm_mode_16_64 3
.end_amdhsa_kernel
```
